```python
import torch

def _softmax(x, axis=-1):
    return torch.softmax(x, dim=axis)
def _gelu(x):
    return torch.nn.functional.gelu(x, approximate="tanh")
def _silu(x):
    return torch.nn.functional.silu(x)
def _sigmoid(x):
    return torch.sigmoid(x)
def _layernorm(x, axis=-1, eps=1e-5):
    m = x.mean(dim=axis, keepdim=True)
    v = x.var(dim=axis, keepdim=True, unbiased=False)
    return (x - m) / torch.sqrt(v + eps)
def _scatter_add(tgt, idx, src, axis=0):
    return tgt.clone().index_add_(axis, idx, src)
def _segment_sum(src, seg, n):
    out = torch.zeros((n,) + src.shape[1:], dtype=src.dtype)
    return out.index_add_(0, seg, src)
def _pad(x, pw):
    flat = tuple(v for pair in reversed(pw) for v in pair)
    return torch.nn.functional.pad(x, flat)

kernel_name = 'gated_mix__linear_kernel_hedgehog__mixer_token_mlp__prompt'

def setup_inputs():

    _w = (lambda a: (lambda t: t.to(torch.bfloat16) if t.is_floating_point() else t)(torch.as_tensor(a)))
    def _A_setup():
        B, S, D, H = 1, 2048, 512, 32
        Dh = D // H
        return {
            "x": _w((lambda *s: torch.randn(*s, dtype=torch.bfloat16) * 0.05)(B, S, D)),
            "wqkv": _w((lambda *s: torch.randn(*s, dtype=torch.bfloat16) * 0.8)(D, 3 * D)),
            "w_phi": _w((lambda *s: torch.randn(*s, dtype=torch.bfloat16) * 0.8)(H, Dh, Dh) * (Dh ** -0.5)),
            "wo": _w((lambda *s: torch.randn(*s, dtype=torch.bfloat16) * 0.05)(D, D)),
        }
    _A_in = _A_setup()

    def _B_setup():
        B, S, D, F = 1, 2048, 512, 1376
        return {
            "x": _w((lambda *s: torch.randn(*s, dtype=torch.bfloat16) * 0.05)(B, S, D)),
            "w1": _w((lambda *s: torch.randn(*s, dtype=torch.bfloat16) * 0.4)(S, F) * (S ** -0.5)),
            "b1": _w((lambda *s: torch.randn(*s, dtype=torch.bfloat16) * 3.2)(F) * 0.02),
            "w2": _w((lambda *s: torch.randn(*s, dtype=torch.bfloat16) * 0.1)(F, S) * (F ** -0.5)),
            "b2": _w((lambda *s: torch.randn(*s, dtype=torch.bfloat16) * 0.4)(S) * 0.02),
        }
    _B_in = _B_setup()

    return {
        "A_x": _A_in["x"],
        "A_wqkv": _A_in["wqkv"],
        "A_w_phi": _A_in["w_phi"],
        "A_wo": _A_in["wo"],
        "B_x": _B_in["x"],
        "B_w1": _B_in["w1"],
        "B_b1": _B_in["b1"],
        "B_w2": _B_in["w2"],
        "B_b2": _B_in["b2"],
        "gate_w": _w((lambda *s: torch.randn(*s, dtype=torch.bfloat16) * 0.05)(512) * 16.0),
    }

def reference(A_x, A_wqkv, A_w_phi, A_wo, B_x, B_w1, B_b1, B_w2, B_b2, gate_w):
    def _A_ref(x, wqkv, w_phi, wo):
        B, S, D = x.shape
        H = 32; Dh = D // H
        qkv = (lambda x, *d: x.permute(*d))((x @ wqkv).reshape(B, S, 3, H, Dh), 2, 0, 3, 1, 4)
        q, k, v = qkv[0], qkv[1], qkv[2]
        pq = torch.einsum("bhsd,hdf->bhsf", q, w_phi)
        pk = torch.einsum("bhsd,hdf->bhsf", k, w_phi)
        phi_q = torch.concatenate([_softmax(pq, axis=-1), _softmax(-pq, axis=-1)], axis=-1)
        phi_k = torch.concatenate([_softmax(pk, axis=-1), _softmax(-pk, axis=-1)], axis=-1)
        kv = torch.einsum("bhsf,bhsd->bhfd", phi_k, v)
        z  = torch.einsum("bhsf->bhf", phi_k)
        num = torch.einsum("bhqf,bhfd->bhqd", phi_q, kv)
        den = torch.einsum("bhqf,bhf->bhq", phi_q, z)[..., None] + 1e-6
        o = num / den
        return (lambda x, *d: x.permute(*d))(o, 0, 2, 1, 3).reshape(B, S, D) @ wo

    def _B_ref(x, w1, b1, w2, b2):
        B, S, D = x.shape
        h = _layernorm(x, axis=-1)
        u = torch.einsum("bsd,sf->bdf", h, w1) + b1
        u = _gelu(u)
        y = torch.einsum("bdf,fs->bds", u, w2) + b2
        return (lambda x, *d: x.permute(*d))(y, 0, 2, 1)

    x = A_x
    g = _sigmoid((x * gate_w).sum(-1, keepdims=True))
    a = _A_ref(x, A_wqkv, A_w_phi, A_wo)
    b = _B_ref(x, B_w1, B_b1, B_w2, B_b2)
    return g * a + (1 - g) * b
```

```asm
; @launch grid=(256,1,1) block=(512,1,1) lds=163840

.amdgcn_target "amdgcn-amd-amdhsa--gfx950"
.text
.globl gated_mix__linear_kernel_hedgehog__mixer_token_mlp__prompt_kernel
.p2align 8
.type gated_mix__linear_kernel_hedgehog__mixer_token_mlp__prompt_kernel,@function
gated_mix__linear_kernel_hedgehog__mixer_token_mlp__prompt_kernel:
  s_cmp_ge_u32 s2, 256
  s_cbranch_scc1 L_end
  s_load_dwordx16 s[52:67], s[0:1], 0
  s_load_dwordx8 s[68:75], s[0:1], 64
  s_load_dwordx2 s[76:77], s[0:1], 96
  v_and_b32 v1, 63, v0
  v_lshrrev_b32 v4, 6, v0
  v_and_b32 v2, 31, v0
  v_bfe_u32 v3, v0, 5, 1
  v_readfirstlane_b32 s3, v4
  s_mov_b32 s10, 2097152
  s_mov_b32 s11, 0x20000
  s_mov_b32 s14, 1572864
  s_mov_b32 s15, 0x20000
  s_mov_b32 s50, 1024
  s_mov_b32 s51, 0x20000
  s_mov_b32 s30, 7340032
  s_mov_b32 s31, 0x20000
  s_mov_b32 s38, 16384
  s_mov_b32 s39, 0x20000
  s_mov_b32 s18, 524288
  s_mov_b32 s19, 0x20000
  s_mov_b32 s22, 5636096
  s_mov_b32 s23, 0x20000
  s_mov_b32 s42, 2752
  s_mov_b32 s43, 0x20000
  s_mov_b32 s26, 5636096
  s_mov_b32 s27, 0x20000
  s_mov_b32 s46, 4096
  s_mov_b32 s47, 0x20000
  s_mov_b32 s34, 2097152
  s_mov_b32 s35, 0x20000
  s_mov_b32 s78, s3
  s_and_b32 s79, s3, 3
  s_and_b32 s80, s2, 7
  s_lshr_b32 s81, s2, 3
  s_lshl_b32 s88, s79, 11
  s_and_b32 s4, s80, 3
  s_lshr_b32 s5, s80, 2
  s_lshl_b32 s82, s4, 6
  s_lshl_b32 s6, s5, 5
  s_add_u32 s82, s82, s6
  s_add_u32 s82, s82, s81
  s_lshl_b32 s83, s4, 3
  s_lshl_b32 s84, s5, 2
  s_mul_i32 s6, s81, 171
  s_lshr_b32 s92, s6, 9
  s_mul_i32 s6, s92, 3
  s_sub_u32 s91, s81, s6
  s_sub_u32 s6, s81, 24
  s_cmp_ge_u32 s81, 24
  s_cselect_b32 s91, 3, s91
  s_cselect_b32 s92, s6, s92
  s_add_u32 s83, s83, s92
  s_add_u32 s84, s84, s91
  s_waitcnt lgkmcnt(0)
  s_mov_b32 s8, s52
  s_mov_b32 s9, s53
  s_mov_b32 s12, s54
  s_mov_b32 s13, s55
  s_mov_b32 s48, s70
  s_mov_b32 s49, s71
  s_mov_b32 s28, s76
  s_mov_b32 s29, s77
  s_mov_b32 s36, s56
  s_mov_b32 s37, s57
  s_mov_b32 s16, s58
  s_mov_b32 s17, s59
  s_mov_b32 s20, s62
  s_mov_b32 s21, s63
  s_mov_b32 s40, s64
  s_mov_b32 s41, s65
  s_mov_b32 s24, s66
  s_mov_b32 s25, s67
  s_mov_b32 s44, s68
  s_mov_b32 s45, s69
  s_mov_b32 s32, s72
  s_mov_b32 s33, s73
  s_cmp_ge_u32 s78, 4
  s_cbranch_scc1 L_loader
  s_setprio 2
  v_lshlrev_b32 v4, 4, v1
  s_lshl_b32 s6, s82, 13
  s_lshl_b32 s4, s79, 11
  s_add_u32 s6, s6, s4
  buffer_load_dwordx4 v[40:43], v4, s[8:11], s6 offen
  buffer_load_dwordx4 v[44:47], v4, s[8:11], s6 offen offset:1024
  buffer_load_dwordx4 v[48:51], v4, s[48:51], 0 offen
  s_getpc_b64 s[4:5]
L_pc3:
  s_sub_u32 s4, s4, L_pc3-gated_mix__linear_kernel_hedgehog__mixer_token_mlp__prompt_kernel
  s_subb_u32 s5, s5, 0
  s_and_b32 s6, s81, 15
  s_lshl_b32 s6, s6, 12
  s_lshl_b32 s7, s79, 10
  s_add_u32 s6, s6, s7
  v_lshlrev_b32 v5, 4, v1
  v_add_u32 v5, s6, v5
  v_min_u32 v5, L_code_end-gated_mix__linear_kernel_hedgehog__mixer_token_mlp__prompt_kernel-16, v5
  v_and_b32 v5, -16, v5
  global_load_dwordx4 v[124:127], v5, s[4:5]
  s_cmp_lg_u32 s79, 0
  s_cbranch_scc1 L_z_1
  v_lshlrev_b32 v5, 2, v1
  v_add_u32 v5, 162816, v5
  v_mov_b32 v6, 0
  ds_write_b32 v5, v6
  s_waitcnt lgkmcnt(0)
L_z_1:
  s_barrier
  s_branch L_c_cut
L_loader:
  v_lshrrev_b32 v11, 3, v1
  v_and_b32 v5, 7, v1
  v_lshlrev_b32 v5, 4, v5
  v_bfe_u32 v6, v1, 4, 1
  v_lshlrev_b32 v6, 6, v6
  v_xor_b32 v10, v5, v6
  v_mov_b32 v13, 0
  s_lshl_b32 s6, s83, 16
  s_lshl_b32 s4, s79, 4
  v_add_u32 v5, s4, v11
  v_lshlrev_b32 v5, 10, v5
  v_add_u32 v5, s6, v5
  v_and_b32 v6, 7, v1
  v_lshrrev_b32 v7, 4, v1
  v_xor_b32 v6, v6, v7
  v_lshl_add_u32 v15, v6, 4, v5
  v_xor_b32 v6, 4, v6
  v_lshl_add_u32 v16, v6, 4, v5
  v_add_u32 v16, 8192, v16
  s_lshl_b32 s6, s84, 7
  s_add_u32 s6, s6, 1024
  s_lshl_b32 s4, s79, 4
  v_add_u32 v5, s4, v11
  s_mov_b32 s5, 3072
  v_mul_lo_u32 v5, v5, s5
  v_add_u32 v5, v5, v10
  v_add_u32 v17, s6, v5
  v_add_u32 v18, 24576, v17
  s_mul_i32 s4, s91, 2
  s_mul_i32 s5, s92, 1
  s_add_u32 s4, s4, s5
  s_and_b32 s4, s4, 7
  s_lshl_b32 s64, s4, 7
  s_mul_i32 s65, s4, 196608
  s_add_u32 s66, s65, 1024
  s_add_u32 m0, s88, 8192
  s_nop 0
  buffer_load_dwordx4 v17, s[12:15], s65 offen  lds
  s_add_u32 m0, s88, 9216
  s_nop 0
  buffer_load_dwordx4 v18, s[12:15], s65 offen  lds
  s_add_u32 m0, s88, 16384
  s_nop 0
  buffer_load_dwordx4 v17, s[12:15], s66 offen  lds
  s_add_u32 m0, s88, 17408
  s_nop 0
  buffer_load_dwordx4 v18, s[12:15], s66 offen  lds
  s_add_u32 m0, s88, 0
  s_nop 0
  buffer_load_dwordx4 v15, s[8:11], s64 offen  lds
  s_add_u32 m0, s88, 1024
  s_nop 0
  buffer_load_dwordx4 v16, s[8:11], s64 offen  lds
  s_add_u32 s64, s64, 128
  s_cmp_eq_u32 s64, 1024
  s_cselect_b32 s64, 0, s64
  s_add_u32 s65, s65, 196608
  s_cmp_eq_u32 s65, 1572864
  s_cselect_b32 s65, 0, s65
  s_add_u32 s66, s65, 1024
  s_barrier
  s_add_u32 m0, s88, 32768
  s_nop 0
  buffer_load_dwordx4 v17, s[12:15], s65 offen  lds
  s_add_u32 m0, s88, 33792
  s_nop 0
  buffer_load_dwordx4 v18, s[12:15], s65 offen  lds
  s_add_u32 m0, s88, 40960
  s_nop 0
  buffer_load_dwordx4 v17, s[12:15], s66 offen  lds
  s_add_u32 m0, s88, 41984
  s_nop 0
  buffer_load_dwordx4 v18, s[12:15], s66 offen  lds
  s_add_u32 m0, s88, 24576
  s_nop 0
  buffer_load_dwordx4 v15, s[8:11], s64 offen  lds
  s_waitcnt vmcnt(10)
  s_add_u32 m0, s88, 25600
  s_nop 0
  buffer_load_dwordx4 v16, s[8:11], s64 offen  lds
  s_add_u32 s64, s64, 128
  s_cmp_eq_u32 s64, 1024
  s_cselect_b32 s64, 0, s64
  s_add_u32 s65, s65, 196608
  s_cmp_eq_u32 s65, 1572864
  s_cselect_b32 s65, 0, s65
  s_add_u32 s66, s65, 1024
  s_waitcnt vmcnt(10)
  s_add_u32 m0, s88, 57344
  s_nop 0
  buffer_load_dwordx4 v17, s[12:15], s65 offen  lds
  s_waitcnt vmcnt(10)
  s_add_u32 m0, s88, 58368
  s_nop 0
  buffer_load_dwordx4 v18, s[12:15], s65 offen  lds
  s_waitcnt vmcnt(10)
  s_add_u32 m0, s88, 65536
  s_nop 0
  buffer_load_dwordx4 v17, s[12:15], s66 offen  lds
  s_waitcnt vmcnt(10)
  s_add_u32 m0, s88, 66560
  s_nop 0
  buffer_load_dwordx4 v18, s[12:15], s66 offen  lds
  s_waitcnt vmcnt(10)
  s_add_u32 m0, s88, 49152
  s_nop 0
  buffer_load_dwordx4 v15, s[8:11], s64 offen  lds
  s_waitcnt vmcnt(10)
  s_add_u32 m0, s88, 50176
  s_nop 0
  buffer_load_dwordx4 v16, s[8:11], s64 offen  lds
  s_add_u32 s64, s64, 128
  s_cmp_eq_u32 s64, 1024
  s_cselect_b32 s64, 0, s64
  s_add_u32 s65, s65, 196608
  s_cmp_eq_u32 s65, 1572864
  s_cselect_b32 s65, 0, s65
  s_add_u32 s66, s65, 1024
  s_waitcnt vmcnt(10)
  s_add_u32 m0, s88, 81920
  s_nop 0
  buffer_load_dwordx4 v17, s[12:15], s65 offen  lds
  s_waitcnt vmcnt(10)
  s_add_u32 m0, s88, 82944
  s_nop 0
  buffer_load_dwordx4 v18, s[12:15], s65 offen  lds
  s_waitcnt vmcnt(10)
  s_add_u32 m0, s88, 90112
  s_nop 0
  buffer_load_dwordx4 v17, s[12:15], s66 offen  lds
  s_waitcnt vmcnt(10)
  s_add_u32 m0, s88, 91136
  s_nop 0
  buffer_load_dwordx4 v18, s[12:15], s66 offen  lds
  s_waitcnt vmcnt(10)
  s_add_u32 m0, s88, 73728
  s_nop 0
  buffer_load_dwordx4 v15, s[8:11], s64 offen  lds
  s_waitcnt vmcnt(10)
  s_add_u32 m0, s88, 74752
  s_nop 0
  buffer_load_dwordx4 v16, s[8:11], s64 offen  lds
  s_add_u32 s64, s64, 128
  s_cmp_eq_u32 s64, 1024
  s_cselect_b32 s64, 0, s64
  s_add_u32 s65, s65, 196608
  s_cmp_eq_u32 s65, 1572864
  s_cselect_b32 s65, 0, s65
  s_add_u32 s66, s65, 1024
  s_branch L_loader_cut
L_c_cut:
  s_lshr_b32 s4, s80, 1
  s_and_b32 s5, s4, 1
  s_sub_u32 s7, 6, s5
  s_lshl_b32 s7, s7, 2
  s_mul_i32 s5, s4, 11
  s_add_u32 s5, s5, 1
  s_lshr_b32 s5, s5, 1
  s_lshr_b32 s6, s81, 2
  s_add_u32 s87, s5, s6
  s_and_b32 s5, s80, 1
  s_lshl_b32 s5, s5, 2
  s_and_b32 s6, s81, 3
  s_xor_b32 s6, s6, 0
  s_add_u32 s86, s5, s6
  s_mov_b32 s85, 0
  s_and_b32 s4, s80, 3
  s_lshl_b32 s89, s4, 3
  s_lshr_b32 s4, s81, 2
  s_add_u32 s89, s89, s4
  s_lshr_b32 s4, s80, 2
  s_lshl_b32 s90, s4, 2
  s_and_b32 s4, s81, 3
  s_add_u32 s90, s90, s4
  s_cmp_lt_u32 s81, s7
  s_cbranch_scc1 L_role_2
  s_sub_u32 s4, s81, s7
  s_mov_b32 s85, 2
  s_cmp_eq_u32 s7, 24
  s_cselect_b32 s5, 4, 12
  s_cmp_ge_u32 s4, s5
  s_cbranch_scc1 L_role_2
  s_mov_b32 s85, 1
  s_and_b32 s5, s80, 1
  s_lshr_b32 s6, s80, 2
  s_lshl_b32 s6, s6, 1
  s_add_u32 s5, s5, s6
  s_mul_i32 s6, s5, 3
  s_lshr_b32 s86, s4, 2
  s_add_u32 s6, s6, s86
  s_add_u32 s5, s5, 12
  s_cmp_eq_u32 s7, 24
  s_cselect_b32 s86, s5, s6
  s_and_b32 s87, s4, 3
L_role_2:
  s_lshl_b32 s4, s84, 5
  s_add_u32 s4, s4, s83
  s_lshl_b32 s4, s4, 6
  s_add_u32 s93, s4, 6488064
  s_lshl_b32 s5, s86, 5
  s_add_u32 s5, s5, s87
  s_lshl_b32 s5, s5, 6
  s_add_u32 s5, s5, 6520832
  s_lshl_b32 s6, s86, 2
  s_add_u32 s6, s6, s87
  s_lshl_b32 s6, s6, 6
  s_add_u32 s6, s6, 6504448
  s_cmp_eq_u32 s85, 1
  s_cselect_b32 s94, s6, s5
  s_cmp_eq_u32 s85, 2
  s_cselect_b32 s94, s93, s94
  s_waitcnt vmcnt(1)
  v_lshlrev_b32 v56, 16, v40
  v_and_b32 v57, 0xffff0000, v40
  v_lshlrev_b32 v58, 16, v41
  v_and_b32 v59, 0xffff0000, v41
  v_lshlrev_b32 v60, 16, v42
  v_and_b32 v61, 0xffff0000, v42
  v_lshlrev_b32 v62, 16, v43
  v_and_b32 v63, 0xffff0000, v43
  v_lshlrev_b32 v64, 16, v44
  v_and_b32 v65, 0xffff0000, v44
  v_lshlrev_b32 v66, 16, v45
  v_and_b32 v67, 0xffff0000, v45
  v_lshlrev_b32 v68, 16, v46
  v_and_b32 v69, 0xffff0000, v46
  v_lshlrev_b32 v70, 16, v47
  v_and_b32 v71, 0xffff0000, v47
  v_lshlrev_b32 v72, 16, v48
  v_and_b32 v73, 0xffff0000, v48
  v_lshlrev_b32 v74, 16, v49
  v_and_b32 v75, 0xffff0000, v49
  v_lshlrev_b32 v76, 16, v50
  v_and_b32 v77, 0xffff0000, v50
  v_lshlrev_b32 v78, 16, v51
  v_and_b32 v79, 0xffff0000, v51
  v_add_f32 v80, v56, v57
  v_mul_f32 v82, v56, v72
  v_add_f32 v80, v80, v58
  v_add_f32 v80, v80, v59
  v_add_f32 v80, v80, v60
  v_add_f32 v80, v80, v61
  v_add_f32 v80, v80, v62
  v_add_f32 v80, v80, v63
  v_fmac_f32 v82, v57, v73
  v_fmac_f32 v82, v58, v74
  v_fmac_f32 v82, v59, v75
  v_fmac_f32 v82, v60, v76
  v_fmac_f32 v82, v61, v77
  v_fmac_f32 v82, v62, v78
  v_fmac_f32 v82, v63, v79
  v_add_f32 v81, v64, v65
  v_mul_f32 v83, v64, v72
  v_add_f32 v81, v81, v66
  v_add_f32 v81, v81, v67
  v_add_f32 v81, v81, v68
  v_add_f32 v81, v81, v69
  v_add_f32 v81, v81, v70
  v_add_f32 v81, v81, v71
  v_fmac_f32 v83, v65, v73
  v_fmac_f32 v83, v66, v74
  v_fmac_f32 v83, v67, v75
  v_fmac_f32 v83, v68, v76
  v_fmac_f32 v83, v69, v77
  v_fmac_f32 v83, v70, v78
  v_fmac_f32 v83, v71, v79
  v_add_f32_dpp v80, v80, v80 row_shr:1 row_mask:0xf bank_mask:0xf bound_ctrl:1
  v_add_f32_dpp v81, v81, v81 row_shr:1 row_mask:0xf bank_mask:0xf bound_ctrl:1
  v_add_f32_dpp v82, v82, v82 row_shr:1 row_mask:0xf bank_mask:0xf bound_ctrl:1
  v_add_f32_dpp v83, v83, v83 row_shr:1 row_mask:0xf bank_mask:0xf bound_ctrl:1
  v_add_f32_dpp v80, v80, v80 row_shr:2 row_mask:0xf bank_mask:0xf bound_ctrl:1
  v_add_f32_dpp v81, v81, v81 row_shr:2 row_mask:0xf bank_mask:0xf bound_ctrl:1
  v_add_f32_dpp v82, v82, v82 row_shr:2 row_mask:0xf bank_mask:0xf bound_ctrl:1
  v_add_f32_dpp v83, v83, v83 row_shr:2 row_mask:0xf bank_mask:0xf bound_ctrl:1
  v_add_f32_dpp v80, v80, v80 row_shr:4 row_mask:0xf bank_mask:0xf bound_ctrl:1
  v_add_f32_dpp v81, v81, v81 row_shr:4 row_mask:0xf bank_mask:0xf bound_ctrl:1
  v_add_f32_dpp v82, v82, v82 row_shr:4 row_mask:0xf bank_mask:0xf bound_ctrl:1
  v_add_f32_dpp v83, v83, v83 row_shr:4 row_mask:0xf bank_mask:0xf bound_ctrl:1
  v_add_f32_dpp v80, v80, v80 row_shr:8 row_mask:0xf bank_mask:0xf bound_ctrl:1
  v_add_f32_dpp v81, v81, v81 row_shr:8 row_mask:0xf bank_mask:0xf bound_ctrl:1
  v_add_f32_dpp v82, v82, v82 row_shr:8 row_mask:0xf bank_mask:0xf bound_ctrl:1
  v_add_f32_dpp v83, v83, v83 row_shr:8 row_mask:0xf bank_mask:0xf bound_ctrl:1
  v_add_f32_dpp v80, v80, v80 row_bcast:15 row_mask:0xa bank_mask:0xf
  v_add_f32_dpp v81, v81, v81 row_bcast:15 row_mask:0xa bank_mask:0xf
  v_add_f32_dpp v82, v82, v82 row_bcast:15 row_mask:0xa bank_mask:0xf
  v_add_f32_dpp v83, v83, v83 row_bcast:15 row_mask:0xa bank_mask:0xf
  v_add_f32_dpp v80, v80, v80 row_bcast:31 row_mask:0xc bank_mask:0xf
  v_add_f32_dpp v81, v81, v81 row_bcast:31 row_mask:0xc bank_mask:0xf
  v_add_f32_dpp v82, v82, v82 row_bcast:31 row_mask:0xc bank_mask:0xf
  v_add_f32_dpp v83, v83, v83 row_bcast:31 row_mask:0xc bank_mask:0xf
  v_readlane_b32 s52, v80, 63
  v_readlane_b32 s53, v81, 63
  v_readlane_b32 s54, v82, 63
  v_readlane_b32 s55, v83, 63
  v_mov_b32 v5, s52
  v_mul_f32 v5, 0xbb000000, v5
  v_add_f32 v56, v56, v5
  v_add_f32 v57, v57, v5
  v_add_f32 v58, v58, v5
  v_add_f32 v59, v59, v5
  v_add_f32 v60, v60, v5
  v_add_f32 v61, v61, v5
  v_add_f32 v62, v62, v5
  v_add_f32 v63, v63, v5
  v_mul_f32 v80, v56, v56
  v_fmac_f32 v80, v57, v57
  v_fmac_f32 v80, v58, v58
  v_fmac_f32 v80, v59, v59
  v_fmac_f32 v80, v60, v60
  v_fmac_f32 v80, v61, v61
  v_fmac_f32 v80, v62, v62
  v_fmac_f32 v80, v63, v63
  v_mov_b32 v5, s53
  v_mul_f32 v5, 0xbb000000, v5
  v_add_f32 v64, v64, v5
  v_add_f32 v65, v65, v5
  v_add_f32 v66, v66, v5
  v_add_f32 v67, v67, v5
  v_add_f32 v68, v68, v5
  v_add_f32 v69, v69, v5
  v_add_f32 v70, v70, v5
  v_add_f32 v71, v71, v5
  v_mul_f32 v81, v64, v64
  v_fmac_f32 v81, v65, v65
  v_fmac_f32 v81, v66, v66
  v_fmac_f32 v81, v67, v67
  v_fmac_f32 v81, v68, v68
  v_fmac_f32 v81, v69, v69
  v_fmac_f32 v81, v70, v70
  v_fmac_f32 v81, v71, v71
  v_add_f32_dpp v80, v80, v80 row_shr:1 row_mask:0xf bank_mask:0xf bound_ctrl:1
  s_nop 0
  v_add_f32_dpp v81, v81, v81 row_shr:1 row_mask:0xf bank_mask:0xf bound_ctrl:1
  v_add_f32_dpp v80, v80, v80 row_shr:2 row_mask:0xf bank_mask:0xf bound_ctrl:1
  s_nop 0
  v_add_f32_dpp v81, v81, v81 row_shr:2 row_mask:0xf bank_mask:0xf bound_ctrl:1
  v_add_f32_dpp v80, v80, v80 row_shr:4 row_mask:0xf bank_mask:0xf bound_ctrl:1
  s_nop 0
  v_add_f32_dpp v81, v81, v81 row_shr:4 row_mask:0xf bank_mask:0xf bound_ctrl:1
  v_add_f32_dpp v80, v80, v80 row_shr:8 row_mask:0xf bank_mask:0xf bound_ctrl:1
  s_nop 0
  v_add_f32_dpp v81, v81, v81 row_shr:8 row_mask:0xf bank_mask:0xf bound_ctrl:1
  v_add_f32_dpp v80, v80, v80 row_bcast:15 row_mask:0xa bank_mask:0xf
  s_nop 0
  v_add_f32_dpp v81, v81, v81 row_bcast:15 row_mask:0xa bank_mask:0xf
  v_add_f32_dpp v80, v80, v80 row_bcast:31 row_mask:0xc bank_mask:0xf
  s_nop 0
  v_add_f32_dpp v81, v81, v81 row_bcast:31 row_mask:0xc bank_mask:0xf
  v_readlane_b32 s95, v80, 63
  v_readlane_b32 s96, v81, 63
  s_lshl_b32 s4, s79, 1
  s_mul_i32 s4, s4, 1088
  s_add_u32 s4, s4, 131072
  v_lshlrev_b32 v48, 4, v1
  v_add_u32 v48, s4, v48
  v_mov_b32 v5, s95
  v_mul_f32 v5, 0x3b000000, v5
  v_add_f32 v5, 0x3727c5ac, v5
  v_rsq_f32 v5, v5
  s_nop 0
  v_mul_f32 v56, v56, v5
  v_mul_f32 v57, v57, v5
  v_mul_f32 v58, v58, v5
  v_mul_f32 v59, v59, v5
  v_mul_f32 v60, v60, v5
  v_mul_f32 v61, v61, v5
  v_mul_f32 v62, v62, v5
  v_mul_f32 v63, v63, v5
  v_cvt_pk_bf16_f32 v40, v56, v57
  v_cvt_pk_bf16_f32 v41, v58, v59
  v_cvt_pk_bf16_f32 v42, v60, v61
  v_cvt_pk_bf16_f32 v43, v62, v63
  ds_write_b128 v48, v[40:43] offset:0
  v_mov_b32 v5, s96
  v_mul_f32 v5, 0x3b000000, v5
  v_add_f32 v5, 0x3727c5ac, v5
  v_rsq_f32 v5, v5
  s_nop 0
  v_mul_f32 v64, v64, v5
  v_mul_f32 v65, v65, v5
  v_mul_f32 v66, v66, v5
  v_mul_f32 v67, v67, v5
  v_mul_f32 v68, v68, v5
  v_mul_f32 v69, v69, v5
  v_mul_f32 v70, v70, v5
  v_mul_f32 v71, v71, v5
  v_cvt_pk_bf16_f32 v44, v64, v65
  v_cvt_pk_bf16_f32 v45, v66, v67
  v_cvt_pk_bf16_f32 v46, v68, v69
  v_cvt_pk_bf16_f32 v47, v70, v71
  ds_write_b128 v48, v[44:47] offset:1088
  s_waitcnt lgkmcnt(0)
  v_mov_b32 v5, 162816
  v_mov_b32 v6, 1
  s_mov_b64 exec, 1
  ds_add_u32 v5, v6
  s_mov_b64 exec, -1
  v_mov_b32 v5, 162816
  s_mov_b32 s7, 1048576
L_ls_3:
  ds_read_b32 v6, v5
  s_waitcnt lgkmcnt(0)
  v_readfirstlane_b32 s4, v6
  s_nop 3
  s_cmp_ge_u32 s4, 4
  s_cbranch_scc1 L_lo_4
  s_sub_u32 s7, s7, 1
  s_cmp_eq_u32 s7, 0
  s_cbranch_scc1 L_lo_4
  s_sleep 1
  s_branch L_ls_3
L_lo_4:
  v_and_b32 v5, 15, v1
  v_lshrrev_b32 v6, 2, v5
  v_mul_u32_u24 v6, 1088, v6
  v_and_b32 v5, 3, v5
  v_lshl_add_u32 v6, v5, 3, v6
  v_lshrrev_b32 v5, 4, v1
  v_lshl_add_u32 v6, v5, 5, v6
  s_lshl_b32 s4, s79, 8
  s_add_u32 s4, s4, 131072
  v_add_u32 v6, s4, v6
  ds_read_b64_tr_b16 v[56:57], v6 offset:0
  ds_read_b64_tr_b16 v[58:59], v6 offset:4352
  ds_read_b64_tr_b16 v[60:61], v6 offset:128
  ds_read_b64_tr_b16 v[62:63], v6 offset:4480
  s_waitcnt lgkmcnt(0)
  s_lshl_b32 s4, s82, 13
  s_lshl_b32 s5, s79, 11
  s_add_u32 s4, s4, s5
  s_add_u32 s4, s4, 0
  v_lshlrev_b32 v5, 4, v1
  buffer_store_dwordx4 v[56:59], v5, s[28:31], s4 offen offset:0 sc1
  buffer_store_dwordx4 v[60:63], v5, s[28:31], s4 offen offset:1024 sc1
  v_mov_b32 v5, s54
  v_mov_b32 v6, s55
  v_cmp_eq_u32 vcc, 0, v1
  s_nop 1
  v_cndmask_b32 v5, v6, v5, vcc
  v_mul_f32 v5, 0xbfb8aa3b, v5
  v_exp_f32 v5, v5
  s_nop 0
  v_add_f32 v5, 1.0, v5
  v_rcp_f32 v4, v5
  s_lshl_b32 s4, s82, 3
  s_lshl_b32 s5, s79, 1
  s_add_u32 s4, s4, s5
  s_lshl_b32 s4, s4, 2
  s_add_u32 s4, s4, 6422528
  v_lshlrev_b32 v6, 2, v1
  s_mov_b64 exec, 3
  buffer_store_dword v4, v6, s[28:31], s4 offen sc1
  s_mov_b64 exec, -1
  v_mov_b32 v88, 0
  v_mov_b32 v89, 0
  v_mov_b32 v90, 0
  v_mov_b32 v91, 0
  s_cmp_lg_u32 s79, 1
  s_cbranch_scc1 L_z_5
  s_mul_i32 s4, s2, 272
  s_add_u32 s4, s4, 6291456
  v_lshlrev_b32 v6, 4, v1
  s_mov_b64 exec, 0x1ffff
  buffer_store_dwordx4 v[88:91], v6, s[28:31], s4 offen sc1
  s_mov_b64 exec, -1
L_z_5:
  s_cmp_lg_u32 s79, 2
  s_cbranch_scc1 L_z_6
  s_mov_b64 exec, 1
  v_mov_b32 v6, s93
  buffer_store_dword v88, v6, s[28:31], 0 offen sc1
  v_mov_b32 v7, s94
  buffer_store_dword v88, v7, s[28:31], 0 offen sc1
  s_mov_b64 exec, -1
L_z_6:
  s_lshr_b32 s5, s79, 1
  s_lshl_b32 s52, s84, 1
  s_add_u32 s52, s52, s5
  v_lshrrev_b32 v5, 4, v2
  v_lshlrev_b32 v5, 9, v5
  v_and_b32 v6, 15, v2
  v_lshl_add_u32 v5, v6, 1, v5
  v_lshl_add_u32 v5, v3, 7, v5
  s_lshl_b32 s4, s52, 10
  buffer_load_ushort v24, v5, s[36:39], s4 offen offset:0
  buffer_load_ushort v25, v5, s[36:39], s4 offen offset:32
  buffer_load_ushort v26, v5, s[36:39], s4 offen offset:64
  buffer_load_ushort v27, v5, s[36:39], s4 offen offset:96
  buffer_load_ushort v28, v5, s[36:39], s4 offen offset:256
  buffer_load_ushort v29, v5, s[36:39], s4 offen offset:288
  buffer_load_ushort v30, v5, s[36:39], s4 offen offset:320
  buffer_load_ushort v31, v5, s[36:39], s4 offen offset:352
  s_lshr_b32 s6, s79, 1
  s_lshl_b32 s6, s6, 6
  v_bfe_u32 v5, v1, 2, 2
  v_lshl_add_u32 v6, v3, 3, v5
  v_lshlrev_b32 v6, 7, v6
  v_lshrrev_b32 v5, 1, v5
  v_lshlrev_b32 v5, 6, v5
  v_xor_b32 v5, s6, v5
  v_add_u32 v6, v6, v5
  v_bfe_u32 v5, v1, 4, 1
  v_lshl_add_u32 v6, v5, 5, v6
  v_and_b32 v5, 3, v1
  v_lshl_add_u32 v120, v5, 3, v6
  v_add_u32 v121, 65536, v120
  s_and_b32 s4, s79, 1
  s_lshl_b32 s4, s4, 5
  v_add_u32 v5, s4, v2
  v_lshlrev_b32 v5, 7, v5
  v_bfe_u32 v6, v2, 1, 3
  v_xor_b32 v6, v6, v3
  v_lshl_add_u32 v5, v6, 4, v5
  v_xor_b32 v112, 0, v5
  v_add_u32 v113, 65536, v112
  v_xor_b32 v114, 32, v5
  v_add_u32 v115, 65536, v114
  v_xor_b32 v116, 64, v5
  v_add_u32 v117, 65536, v116
  v_xor_b32 v118, 96, v5
  v_add_u32 v119, 65536, v118
  v_cmp_gt_u32 s[54:55], 16, v2
  s_mov_b32 s53, 0x3fb8aa3b
  v_and_b32 v7, 15, v2
  v_lshlrev_b32 v6, 2, v3
  v_sub_u32 v7, v7, v6
  v_mov_b32 v4, 0x3f80
  v_subrev_u32 v5, 0, v7
  v_cmp_gt_u32 vcc, 2, v5
  v_lshlrev_b32 v5, 4, v5
  v_lshlrev_b32 v5, v5, v4
  v_cndmask_b32 v5, 0, v5, vcc
  v_cndmask_b32 v104, 0, v5, s[54:55]
  v_cndmask_b32 v108, v5, 0, s[54:55]
  v_subrev_u32 v5, 2, v7
  v_cmp_gt_u32 vcc, 2, v5
  v_lshlrev_b32 v5, 4, v5
  v_lshlrev_b32 v5, v5, v4
  v_cndmask_b32 v5, 0, v5, vcc
  v_cndmask_b32 v105, 0, v5, s[54:55]
  v_cndmask_b32 v109, v5, 0, s[54:55]
  v_subrev_u32 v5, 8, v7
  v_cmp_gt_u32 vcc, 2, v5
  v_lshlrev_b32 v5, 4, v5
  v_lshlrev_b32 v5, v5, v4
  v_cndmask_b32 v5, 0, v5, vcc
  v_cndmask_b32 v106, 0, v5, s[54:55]
  v_cndmask_b32 v110, v5, 0, s[54:55]
  v_subrev_u32 v5, 10, v7
  v_cmp_gt_u32 vcc, 2, v5
  v_lshlrev_b32 v5, 4, v5
  v_lshlrev_b32 v5, v5, v4
  v_cndmask_b32 v5, 0, v5, vcc
  v_cndmask_b32 v107, 0, v5, s[54:55]
  v_cndmask_b32 v111, v5, 0, s[54:55]
  s_waitcnt lgkmcnt(0)
  s_barrier
  ds_read_b128 a[0:3], v112 offset:0
  ds_read_b64_tr_b16 a[4:5], v120 offset:8192
  ds_read_b64_tr_b16 a[6:7], v120 offset:8704
  ds_read_b64_tr_b16 a[8:9], v120 offset:16384
  ds_read_b64_tr_b16 a[10:11], v120 offset:16896
  ds_read_b128 a[12:15], v114 offset:0
  ds_read_b64_tr_b16 a[16:17], v120 offset:10240
  ds_read_b64_tr_b16 a[18:19], v120 offset:10752
  ds_read_b64_tr_b16 a[20:21], v120 offset:18432
  ds_read_b64_tr_b16 a[22:23], v120 offset:18944
  ds_read_b128 a[24:27], v116 offset:0
  ds_read_b64_tr_b16 a[28:29], v120 offset:12288
  ds_read_b64_tr_b16 a[30:31], v120 offset:12800
  ds_read_b64_tr_b16 a[32:33], v120 offset:20480
  ds_read_b64_tr_b16 a[34:35], v120 offset:20992
  ds_read_b128 a[36:39], v118 offset:0
  ds_read_b64_tr_b16 a[40:41], v120 offset:14336
  ds_read_b64_tr_b16 a[42:43], v120 offset:14848
  ds_read_b64_tr_b16 a[44:45], v120 offset:22528
  ds_read_b64_tr_b16 a[46:47], v120 offset:23040
  s_waitcnt lgkmcnt(0)
  s_barrier
  s_waitcnt vmcnt(8)
  v_mov_b32 v5, 162820
  v_mov_b32 v6, 1
  s_mov_b64 exec, 1
  ds_add_rtn_u32 v7, v5, v6
  s_waitcnt lgkmcnt(0)
  v_readfirstlane_b32 s4, v7
  s_nop 3
  s_cmp_lg_u32 s4, 3
  s_cbranch_scc1 L_el_7
  s_lshl_b32 s4, s80, 5
  v_mov_b32 v5, s4
  global_atomic_add v5, v6, s[74:75]
L_el_7:
  s_mov_b64 exec, -1
  v_mfma_f32_32x32x16_bf16 a[96:111], a[4:7], a[0:3], 0
  ds_read_b128 a[48:51], v112 offset:24576
  ds_read_b64_tr_b16 a[52:53], v120 offset:32768
  ds_read_b64_tr_b16 a[54:55], v120 offset:33280
  ds_read_b64_tr_b16 a[56:57], v120 offset:40960
  ds_read_b64_tr_b16 a[58:59], v120 offset:41472
  v_mfma_f32_32x32x16_bf16 a[112:127], a[0:3], a[8:11], 0
  ds_read_b128 a[60:63], v114 offset:24576
  ds_read_b64_tr_b16 a[64:65], v120 offset:34816
  ds_read_b64_tr_b16 a[66:67], v120 offset:35328
  ds_read_b64_tr_b16 a[68:69], v120 offset:43008
  ds_read_b64_tr_b16 a[70:71], v120 offset:43520
  v_mfma_f32_32x32x16_bf16 a[96:111], a[16:19], a[12:15], a[96:111]
  ds_read_b128 a[72:75], v116 offset:24576
  ds_read_b64_tr_b16 a[76:77], v120 offset:36864
  ds_read_b64_tr_b16 a[78:79], v120 offset:37376
  ds_read_b64_tr_b16 a[80:81], v120 offset:45056
  ds_read_b64_tr_b16 a[82:83], v120 offset:45568
  v_mfma_f32_32x32x16_bf16 a[112:127], a[12:15], a[20:23], a[112:127]
  ds_read_b128 a[84:87], v118 offset:24576
  ds_read_b64_tr_b16 a[88:89], v120 offset:38912
  ds_read_b64_tr_b16 a[90:91], v120 offset:39424
  ds_read_b64_tr_b16 a[92:93], v120 offset:47104
  ds_read_b64_tr_b16 a[94:95], v120 offset:47616
  v_mfma_f32_32x32x16_bf16 a[96:111], a[28:31], a[24:27], a[96:111]
  v_mfma_f32_32x32x16_bf16 a[112:127], a[24:27], a[32:35], a[112:127]
  v_mfma_f32_32x32x16_bf16 a[96:111], a[40:43], a[36:39], a[96:111]
  v_mfma_f32_32x32x16_bf16 a[112:127], a[36:39], a[44:47], a[112:127]
  s_waitcnt lgkmcnt(0)
  s_barrier
  v_mfma_f32_32x32x16_bf16 a[96:111], a[52:55], a[48:51], a[96:111]
  ds_read_b128 a[0:3], v112 offset:49152
  ds_read_b64_tr_b16 a[4:5], v120 offset:57344
  ds_read_b64_tr_b16 a[6:7], v120 offset:57856
  ds_read_b64_tr_b16 a[8:9], v121 offset:0
  ds_read_b64_tr_b16 a[10:11], v121 offset:512
  v_mfma_f32_32x32x16_bf16 a[112:127], a[48:51], a[56:59], a[112:127]
  ds_read_b128 a[12:15], v114 offset:49152
  ds_read_b64_tr_b16 a[16:17], v120 offset:59392
  ds_read_b64_tr_b16 a[18:19], v120 offset:59904
  ds_read_b64_tr_b16 a[20:21], v121 offset:2048
  ds_read_b64_tr_b16 a[22:23], v121 offset:2560
  v_mfma_f32_32x32x16_bf16 a[96:111], a[64:67], a[60:63], a[96:111]
  ds_read_b128 a[24:27], v116 offset:49152
  ds_read_b64_tr_b16 a[28:29], v120 offset:61440
  ds_read_b64_tr_b16 a[30:31], v120 offset:61952
  ds_read_b64_tr_b16 a[32:33], v121 offset:4096
  ds_read_b64_tr_b16 a[34:35], v121 offset:4608
  v_mfma_f32_32x32x16_bf16 a[112:127], a[60:63], a[68:71], a[112:127]
  ds_read_b128 a[36:39], v118 offset:49152
  ds_read_b64_tr_b16 a[40:41], v120 offset:63488
  ds_read_b64_tr_b16 a[42:43], v120 offset:64000
  ds_read_b64_tr_b16 a[44:45], v121 offset:6144
  ds_read_b64_tr_b16 a[46:47], v121 offset:6656
  v_mfma_f32_32x32x16_bf16 a[96:111], a[76:79], a[72:75], a[96:111]
  v_mfma_f32_32x32x16_bf16 a[112:127], a[72:75], a[80:83], a[112:127]
  v_mfma_f32_32x32x16_bf16 a[96:111], a[88:91], a[84:87], a[96:111]
  v_mfma_f32_32x32x16_bf16 a[112:127], a[84:87], a[92:95], a[112:127]
  s_waitcnt lgkmcnt(0)
  s_barrier
  v_mfma_f32_32x32x16_bf16 a[96:111], a[4:7], a[0:3], a[96:111]
  ds_read_b128 a[48:51], v113 offset:8192
  ds_read_b64_tr_b16 a[52:53], v121 offset:16384
  ds_read_b64_tr_b16 a[54:55], v121 offset:16896
  ds_read_b64_tr_b16 a[56:57], v121 offset:24576
  ds_read_b64_tr_b16 a[58:59], v121 offset:25088
  v_mfma_f32_32x32x16_bf16 a[112:127], a[0:3], a[8:11], a[112:127]
  ds_read_b128 a[60:63], v115 offset:8192
  ds_read_b64_tr_b16 a[64:65], v121 offset:18432
  ds_read_b64_tr_b16 a[66:67], v121 offset:18944
  ds_read_b64_tr_b16 a[68:69], v121 offset:26624
  ds_read_b64_tr_b16 a[70:71], v121 offset:27136
  v_mfma_f32_32x32x16_bf16 a[96:111], a[16:19], a[12:15], a[96:111]
  ds_read_b128 a[72:75], v117 offset:8192
  ds_read_b64_tr_b16 a[76:77], v121 offset:20480
  ds_read_b64_tr_b16 a[78:79], v121 offset:20992
  ds_read_b64_tr_b16 a[80:81], v121 offset:28672
  ds_read_b64_tr_b16 a[82:83], v121 offset:29184
  v_mfma_f32_32x32x16_bf16 a[112:127], a[12:15], a[20:23], a[112:127]
  ds_read_b128 a[84:87], v119 offset:8192
  ds_read_b64_tr_b16 a[88:89], v121 offset:22528
  ds_read_b64_tr_b16 a[90:91], v121 offset:23040
  ds_read_b64_tr_b16 a[92:93], v121 offset:30720
  ds_read_b64_tr_b16 a[94:95], v121 offset:31232
  v_mfma_f32_32x32x16_bf16 a[96:111], a[28:31], a[24:27], a[96:111]
  v_mfma_f32_32x32x16_bf16 a[112:127], a[24:27], a[32:35], a[112:127]
  v_mfma_f32_32x32x16_bf16 a[96:111], a[40:43], a[36:39], a[96:111]
  v_mfma_f32_32x32x16_bf16 a[112:127], a[36:39], a[44:47], a[112:127]
  s_waitcnt lgkmcnt(0)
  s_barrier
  v_mfma_f32_32x32x16_bf16 a[96:111], a[52:55], a[48:51], a[96:111]
  ds_read_b128 a[0:3], v113 offset:32768
  ds_read_b64_tr_b16 a[4:5], v121 offset:40960
  ds_read_b64_tr_b16 a[6:7], v121 offset:41472
  ds_read_b64_tr_b16 a[8:9], v121 offset:49152
  ds_read_b64_tr_b16 a[10:11], v121 offset:49664
  v_mfma_f32_32x32x16_bf16 a[112:127], a[48:51], a[56:59], a[112:127]
  ds_read_b128 a[12:15], v115 offset:32768
  ds_read_b64_tr_b16 a[16:17], v121 offset:43008
  ds_read_b64_tr_b16 a[18:19], v121 offset:43520
  ds_read_b64_tr_b16 a[20:21], v121 offset:51200
  ds_read_b64_tr_b16 a[22:23], v121 offset:51712
  v_mfma_f32_32x32x16_bf16 a[96:111], a[64:67], a[60:63], a[96:111]
  ds_read_b128 a[24:27], v117 offset:32768
  ds_read_b64_tr_b16 a[28:29], v121 offset:45056
  ds_read_b64_tr_b16 a[30:31], v121 offset:45568
  ds_read_b64_tr_b16 a[32:33], v121 offset:53248
  ds_read_b64_tr_b16 a[34:35], v121 offset:53760
  v_mfma_f32_32x32x16_bf16 a[112:127], a[60:63], a[68:71], a[112:127]
  ds_read_b128 a[36:39], v119 offset:32768
  ds_read_b64_tr_b16 a[40:41], v121 offset:47104
  ds_read_b64_tr_b16 a[42:43], v121 offset:47616
  ds_read_b64_tr_b16 a[44:45], v121 offset:55296
  ds_read_b64_tr_b16 a[46:47], v121 offset:55808
  v_mfma_f32_32x32x16_bf16 a[96:111], a[76:79], a[72:75], a[96:111]
  v_mfma_f32_32x32x16_bf16 a[112:127], a[72:75], a[80:83], a[112:127]
  v_mfma_f32_32x32x16_bf16 a[96:111], a[88:91], a[84:87], a[96:111]
  v_mfma_f32_32x32x16_bf16 a[112:127], a[84:87], a[92:95], a[112:127]
  s_waitcnt lgkmcnt(0)
  s_barrier
  v_mfma_f32_32x32x16_bf16 a[96:111], a[4:7], a[0:3], a[96:111]
  ds_read_b128 a[48:51], v112 offset:0
  ds_read_b64_tr_b16 a[52:53], v120 offset:8192
  ds_read_b64_tr_b16 a[54:55], v120 offset:8704
  ds_read_b64_tr_b16 a[56:57], v120 offset:16384
  ds_read_b64_tr_b16 a[58:59], v120 offset:16896
  v_mfma_f32_32x32x16_bf16 a[112:127], a[0:3], a[8:11], a[112:127]
  ds_read_b128 a[60:63], v114 offset:0
  ds_read_b64_tr_b16 a[64:65], v120 offset:10240
  ds_read_b64_tr_b16 a[66:67], v120 offset:10752
  ds_read_b64_tr_b16 a[68:69], v120 offset:18432
  ds_read_b64_tr_b16 a[70:71], v120 offset:18944
  v_mfma_f32_32x32x16_bf16 a[96:111], a[16:19], a[12:15], a[96:111]
  ds_read_b128 a[72:75], v116 offset:0
  ds_read_b64_tr_b16 a[76:77], v120 offset:12288
  ds_read_b64_tr_b16 a[78:79], v120 offset:12800
  ds_read_b64_tr_b16 a[80:81], v120 offset:20480
  ds_read_b64_tr_b16 a[82:83], v120 offset:20992
  v_mfma_f32_32x32x16_bf16 a[112:127], a[12:15], a[20:23], a[112:127]
  ds_read_b128 a[84:87], v118 offset:0
  ds_read_b64_tr_b16 a[88:89], v120 offset:14336
  ds_read_b64_tr_b16 a[90:91], v120 offset:14848
  ds_read_b64_tr_b16 a[92:93], v120 offset:22528
  ds_read_b64_tr_b16 a[94:95], v120 offset:23040
  v_mfma_f32_32x32x16_bf16 a[96:111], a[28:31], a[24:27], a[96:111]
  v_mfma_f32_32x32x16_bf16 a[112:127], a[24:27], a[32:35], a[112:127]
  v_mfma_f32_32x32x16_bf16 a[96:111], a[40:43], a[36:39], a[96:111]
  v_mfma_f32_32x32x16_bf16 a[112:127], a[36:39], a[44:47], a[112:127]
  s_waitcnt lgkmcnt(0)
  s_barrier
  v_mfma_f32_32x32x16_bf16 a[96:111], a[52:55], a[48:51], a[96:111]
  ds_read_b128 a[0:3], v112 offset:24576
  ds_read_b64_tr_b16 a[4:5], v120 offset:32768
  ds_read_b64_tr_b16 a[6:7], v120 offset:33280
  ds_read_b64_tr_b16 a[8:9], v120 offset:40960
  ds_read_b64_tr_b16 a[10:11], v120 offset:41472
  v_mfma_f32_32x32x16_bf16 a[112:127], a[48:51], a[56:59], a[112:127]
  ds_read_b128 a[12:15], v114 offset:24576
  ds_read_b64_tr_b16 a[16:17], v120 offset:34816
  ds_read_b64_tr_b16 a[18:19], v120 offset:35328
  ds_read_b64_tr_b16 a[20:21], v120 offset:43008
  ds_read_b64_tr_b16 a[22:23], v120 offset:43520
  v_mfma_f32_32x32x16_bf16 a[96:111], a[64:67], a[60:63], a[96:111]
  ds_read_b128 a[24:27], v116 offset:24576
  ds_read_b64_tr_b16 a[28:29], v120 offset:36864
  ds_read_b64_tr_b16 a[30:31], v120 offset:37376
  ds_read_b64_tr_b16 a[32:33], v120 offset:45056
  ds_read_b64_tr_b16 a[34:35], v120 offset:45568
  v_mfma_f32_32x32x16_bf16 a[112:127], a[60:63], a[68:71], a[112:127]
  ds_read_b128 a[36:39], v118 offset:24576
  ds_read_b64_tr_b16 a[40:41], v120 offset:38912
  ds_read_b64_tr_b16 a[42:43], v120 offset:39424
  ds_read_b64_tr_b16 a[44:45], v120 offset:47104
  ds_read_b64_tr_b16 a[46:47], v120 offset:47616
  v_mfma_f32_32x32x16_bf16 a[96:111], a[76:79], a[72:75], a[96:111]
  v_mfma_f32_32x32x16_bf16 a[112:127], a[72:75], a[80:83], a[112:127]
  v_mfma_f32_32x32x16_bf16 a[96:111], a[88:91], a[84:87], a[96:111]
  v_mfma_f32_32x32x16_bf16 a[112:127], a[84:87], a[92:95], a[112:127]
  s_waitcnt lgkmcnt(0)
  s_barrier
  v_mfma_f32_32x32x16_bf16 a[96:111], a[4:7], a[0:3], a[96:111]
  ds_read_b128 a[48:51], v112 offset:49152
  ds_read_b64_tr_b16 a[52:53], v120 offset:57344
  ds_read_b64_tr_b16 a[54:55], v120 offset:57856
  ds_read_b64_tr_b16 a[56:57], v121 offset:0
  ds_read_b64_tr_b16 a[58:59], v121 offset:512
  v_mfma_f32_32x32x16_bf16 a[112:127], a[0:3], a[8:11], a[112:127]
  ds_read_b128 a[60:63], v114 offset:49152
  ds_read_b64_tr_b16 a[64:65], v120 offset:59392
  ds_read_b64_tr_b16 a[66:67], v120 offset:59904
  ds_read_b64_tr_b16 a[68:69], v121 offset:2048
  ds_read_b64_tr_b16 a[70:71], v121 offset:2560
  v_mfma_f32_32x32x16_bf16 a[96:111], a[16:19], a[12:15], a[96:111]
  ds_read_b128 a[72:75], v116 offset:49152
  ds_read_b64_tr_b16 a[76:77], v120 offset:61440
  ds_read_b64_tr_b16 a[78:79], v120 offset:61952
  ds_read_b64_tr_b16 a[80:81], v121 offset:4096
  ds_read_b64_tr_b16 a[82:83], v121 offset:4608
  v_mfma_f32_32x32x16_bf16 a[112:127], a[12:15], a[20:23], a[112:127]
  ds_read_b128 a[84:87], v118 offset:49152
  ds_read_b64_tr_b16 a[88:89], v120 offset:63488
  ds_read_b64_tr_b16 a[90:91], v120 offset:64000
  ds_read_b64_tr_b16 a[92:93], v121 offset:6144
  ds_read_b64_tr_b16 a[94:95], v121 offset:6656
  v_mfma_f32_32x32x16_bf16 a[96:111], a[28:31], a[24:27], a[96:111]
  v_mfma_f32_32x32x16_bf16 a[112:127], a[24:27], a[32:35], a[112:127]
  v_mfma_f32_32x32x16_bf16 a[96:111], a[40:43], a[36:39], a[96:111]
  v_mfma_f32_32x32x16_bf16 a[112:127], a[36:39], a[44:47], a[112:127]
  s_waitcnt lgkmcnt(0)
  s_barrier
  v_mfma_f32_32x32x16_bf16 a[96:111], a[52:55], a[48:51], a[96:111]
  v_mfma_f32_32x32x16_bf16 a[112:127], a[48:51], a[56:59], a[112:127]
  v_mfma_f32_32x32x16_bf16 a[96:111], a[64:67], a[60:63], a[96:111]
  v_mfma_f32_32x32x16_bf16 a[112:127], a[60:63], a[68:71], a[112:127]
  v_mfma_f32_32x32x16_bf16 a[96:111], a[76:79], a[72:75], a[96:111]
  v_mfma_f32_32x32x16_bf16 a[112:127], a[72:75], a[80:83], a[112:127]
  v_mfma_f32_32x32x16_bf16 a[96:111], a[88:91], a[84:87], a[96:111]
  v_mfma_f32_32x32x16_bf16 a[112:127], a[84:87], a[92:95], a[112:127]
  s_branch L_fm_skip
L_fm:
  v_mfma_f32_32x32x16_bf16 v[40:55], v[96:99], v[16:19], 0
  v_mfma_f32_32x32x16_bf16 v[40:55], v[100:103], v[20:23], v[40:55]
  s_nop 11
  v_max3_f32 v88, v40, v41, v42
  v_max3_f32 v89, v48, v49, v50
  v_min3_f32 v90, v40, v41, v42
  v_min3_f32 v91, v48, v49, v50
  v_max3_f32 v88, v88, v43, v44
  v_max3_f32 v89, v89, v51, v52
  v_min3_f32 v90, v90, v43, v44
  v_min3_f32 v91, v91, v51, v52
  v_max3_f32 v88, v88, v45, v46
  v_max3_f32 v89, v89, v53, v54
  v_min3_f32 v90, v90, v45, v46
  v_min3_f32 v91, v91, v53, v54
  v_max_f32 v88, v88, v47
  v_max_f32 v89, v89, v55
  v_min_f32 v90, v90, v47
  v_min_f32 v91, v91, v55
  v_permlane32_swap_b32 v88, v89
  s_nop 0
  v_permlane32_swap_b32 v90, v91
  v_max_f32 v88, v88, v89
  v_min_f32 v90, v90, v91
  v_mov_b32 v89, v88
  v_mov_b32 v91, v90
  s_nop 0
  v_permlane32_swap_b32 v88, v89
  v_permlane32_swap_b32 v90, v91
  v_mul_f32_e64 v88, -s53, v88
  v_mul_f32 v90, s53, v90
  v_mul_f32_e64 v89, -s53, v89
  v_mul_f32 v91, s53, v91
  v_mov_b32 v92, s53
  v_pk_fma_f32 v[56:57], v[40:41], v[92:93], v[88:89] op_sel:[0,0,0] op_sel_hi:[1,0,0]
  v_pk_fma_f32 v[72:73], v[40:41], v[92:93], v[90:91] op_sel:[0,0,0] op_sel_hi:[1,0,0] neg_lo:[0,1,0] neg_hi:[0,1,0]
  v_pk_fma_f32 v[58:59], v[42:43], v[92:93], v[88:89] op_sel:[0,0,0] op_sel_hi:[1,0,0]
  v_pk_fma_f32 v[74:75], v[42:43], v[92:93], v[90:91] op_sel:[0,0,0] op_sel_hi:[1,0,0] neg_lo:[0,1,0] neg_hi:[0,1,0]
  v_pk_fma_f32 v[60:61], v[44:45], v[92:93], v[88:89] op_sel:[0,0,0] op_sel_hi:[1,0,0]
  v_pk_fma_f32 v[76:77], v[44:45], v[92:93], v[90:91] op_sel:[0,0,0] op_sel_hi:[1,0,0] neg_lo:[0,1,0] neg_hi:[0,1,0]
  v_pk_fma_f32 v[62:63], v[46:47], v[92:93], v[88:89] op_sel:[0,0,0] op_sel_hi:[1,0,0]
  v_pk_fma_f32 v[78:79], v[46:47], v[92:93], v[90:91] op_sel:[0,0,0] op_sel_hi:[1,0,0] neg_lo:[0,1,0] neg_hi:[0,1,0]
  v_pk_fma_f32 v[64:65], v[48:49], v[92:93], v[88:89] op_sel:[0,0,1] op_sel_hi:[1,0,1]
  v_pk_fma_f32 v[80:81], v[48:49], v[92:93], v[90:91] op_sel:[0,0,1] op_sel_hi:[1,0,1] neg_lo:[0,1,0] neg_hi:[0,1,0]
  v_pk_fma_f32 v[66:67], v[50:51], v[92:93], v[88:89] op_sel:[0,0,1] op_sel_hi:[1,0,1]
  v_pk_fma_f32 v[82:83], v[50:51], v[92:93], v[90:91] op_sel:[0,0,1] op_sel_hi:[1,0,1] neg_lo:[0,1,0] neg_hi:[0,1,0]
  v_pk_fma_f32 v[68:69], v[52:53], v[92:93], v[88:89] op_sel:[0,0,1] op_sel_hi:[1,0,1]
  v_pk_fma_f32 v[84:85], v[52:53], v[92:93], v[90:91] op_sel:[0,0,1] op_sel_hi:[1,0,1] neg_lo:[0,1,0] neg_hi:[0,1,0]
  v_pk_fma_f32 v[70:71], v[54:55], v[92:93], v[88:89] op_sel:[0,0,1] op_sel_hi:[1,0,1]
  v_pk_fma_f32 v[86:87], v[54:55], v[92:93], v[90:91] op_sel:[0,0,1] op_sel_hi:[1,0,1] neg_lo:[0,1,0] neg_hi:[0,1,0]
  v_exp_f32 v56, v56
  v_exp_f32 v72, v72
  v_exp_f32 v57, v57
  v_exp_f32 v73, v73
  v_exp_f32 v58, v58
  v_exp_f32 v74, v74
  v_exp_f32 v59, v59
  v_exp_f32 v75, v75
  v_exp_f32 v60, v60
  v_exp_f32 v76, v76
  v_exp_f32 v61, v61
  v_exp_f32 v77, v77
  v_exp_f32 v62, v62
  v_exp_f32 v78, v78
  v_exp_f32 v63, v63
  v_exp_f32 v79, v79
  v_exp_f32 v64, v64
  v_exp_f32 v80, v80
  v_exp_f32 v65, v65
  v_exp_f32 v81, v81
  v_exp_f32 v66, v66
  v_exp_f32 v82, v82
  v_exp_f32 v67, v67
  v_exp_f32 v83, v83
  v_exp_f32 v68, v68
  v_exp_f32 v84, v84
  v_exp_f32 v69, v69
  v_exp_f32 v85, v85
  v_exp_f32 v70, v70
  v_exp_f32 v86, v86
  v_exp_f32 v71, v71
  v_exp_f32 v87, v87
  v_pk_add_f32 v[40:41], v[56:57], v[58:59]
  v_pk_add_f32 v[42:43], v[60:61], v[62:63]
  v_pk_add_f32 v[44:45], v[72:73], v[74:75]
  v_pk_add_f32 v[46:47], v[76:77], v[78:79]
  v_pk_add_f32 v[48:49], v[64:65], v[66:67]
  v_pk_add_f32 v[50:51], v[68:69], v[70:71]
  v_pk_add_f32 v[52:53], v[80:81], v[82:83]
  v_pk_add_f32 v[54:55], v[84:85], v[86:87]
  v_pk_add_f32 v[40:41], v[40:41], v[42:43]
  v_pk_add_f32 v[44:45], v[44:45], v[46:47]
  v_pk_add_f32 v[48:49], v[48:49], v[50:51]
  v_pk_add_f32 v[52:53], v[52:53], v[54:55]
  v_add_f32 v88, v40, v41
  v_add_f32 v90, v44, v45
  v_add_f32 v89, v48, v49
  v_add_f32 v91, v52, v53
  s_nop 0
  v_permlane32_swap_b32 v88, v89
  v_permlane32_swap_b32 v90, v91
  v_add_f32 v88, v88, v89
  v_add_f32 v90, v90, v91
  v_mov_b32 v89, v88
  v_mov_b32 v91, v90
  s_nop 0
  v_permlane32_swap_b32 v88, v89
  v_permlane32_swap_b32 v90, v91
  v_rcp_f32 v92, v88
  v_rcp_f32 v93, v89
  v_rcp_f32 v94, v90
  v_rcp_f32 v95, v91
  v_pk_mul_f32 v[56:57], v[56:57], v[92:93] op_sel:[0,0] op_sel_hi:[1,0]
  v_pk_mul_f32 v[72:73], v[72:73], v[94:95] op_sel:[0,0] op_sel_hi:[1,0]
  v_pk_mul_f32 v[58:59], v[58:59], v[92:93] op_sel:[0,0] op_sel_hi:[1,0]
  v_pk_mul_f32 v[74:75], v[74:75], v[94:95] op_sel:[0,0] op_sel_hi:[1,0]
  v_pk_mul_f32 v[60:61], v[60:61], v[92:93] op_sel:[0,0] op_sel_hi:[1,0]
  v_pk_mul_f32 v[76:77], v[76:77], v[94:95] op_sel:[0,0] op_sel_hi:[1,0]
  v_pk_mul_f32 v[62:63], v[62:63], v[92:93] op_sel:[0,0] op_sel_hi:[1,0]
  v_pk_mul_f32 v[78:79], v[78:79], v[94:95] op_sel:[0,0] op_sel_hi:[1,0]
  v_pk_mul_f32 v[64:65], v[64:65], v[92:93] op_sel:[0,1] op_sel_hi:[1,1]
  v_pk_mul_f32 v[80:81], v[80:81], v[94:95] op_sel:[0,1] op_sel_hi:[1,1]
  v_pk_mul_f32 v[66:67], v[66:67], v[92:93] op_sel:[0,1] op_sel_hi:[1,1]
  v_pk_mul_f32 v[82:83], v[82:83], v[94:95] op_sel:[0,1] op_sel_hi:[1,1]
  v_pk_mul_f32 v[68:69], v[68:69], v[92:93] op_sel:[0,1] op_sel_hi:[1,1]
  v_pk_mul_f32 v[84:85], v[84:85], v[94:95] op_sel:[0,1] op_sel_hi:[1,1]
  v_pk_mul_f32 v[70:71], v[70:71], v[92:93] op_sel:[0,1] op_sel_hi:[1,1]
  v_pk_mul_f32 v[86:87], v[86:87], v[94:95] op_sel:[0,1] op_sel_hi:[1,1]
  v_cvt_pk_bf16_f32 v24, v56, v57
  v_cvt_pk_bf16_f32 v28, v72, v73
  v_cvt_pk_bf16_f32 v25, v58, v59
  v_cvt_pk_bf16_f32 v29, v74, v75
  v_cvt_pk_bf16_f32 v26, v60, v61
  v_cvt_pk_bf16_f32 v30, v76, v77
  v_cvt_pk_bf16_f32 v27, v62, v63
  v_cvt_pk_bf16_f32 v31, v78, v79
  v_cvt_pk_bf16_f32 v32, v64, v65
  v_cvt_pk_bf16_f32 v36, v80, v81
  v_cvt_pk_bf16_f32 v33, v66, v67
  v_cvt_pk_bf16_f32 v37, v82, v83
  v_cvt_pk_bf16_f32 v34, v68, v69
  v_cvt_pk_bf16_f32 v38, v84, v85
  v_cvt_pk_bf16_f32 v35, v70, v71
  v_cvt_pk_bf16_f32 v39, v86, v87
  s_setpc_b64 s[56:57]
L_fm_ret:
L_fm_skip:
  s_getpc_b64 s[58:59]
L_pc1:
  s_sub_u32 s58, s58, L_pc1-L_fm
  s_subb_u32 s59, s59, 0
  s_waitcnt vmcnt(0)
  v_lshl_or_b32 v5, v25, 16, v24
  v_cndmask_b32 v96, 0, v5, s[54:55]
  v_cndmask_b32 v100, v5, 0, s[54:55]
  v_lshl_or_b32 v5, v27, 16, v26
  v_cndmask_b32 v97, 0, v5, s[54:55]
  v_cndmask_b32 v101, v5, 0, s[54:55]
  v_lshl_or_b32 v5, v29, 16, v28
  v_cndmask_b32 v98, 0, v5, s[54:55]
  v_cndmask_b32 v102, v5, 0, s[54:55]
  v_lshl_or_b32 v5, v31, 16, v30
  v_cndmask_b32 v99, 0, v5, s[54:55]
  v_cndmask_b32 v103, v5, 0, s[54:55]
  v_accvgpr_read_b32 v40, a96
  v_accvgpr_read_b32 v41, a97
  v_accvgpr_read_b32 v42, a98
  v_accvgpr_read_b32 v43, a99
  v_accvgpr_read_b32 v44, a100
  v_accvgpr_read_b32 v45, a101
  v_accvgpr_read_b32 v46, a102
  v_accvgpr_read_b32 v47, a103
  v_accvgpr_read_b32 v48, a104
  v_accvgpr_read_b32 v49, a105
  v_accvgpr_read_b32 v50, a106
  v_accvgpr_read_b32 v51, a107
  v_accvgpr_read_b32 v52, a108
  v_accvgpr_read_b32 v53, a109
  v_accvgpr_read_b32 v54, a110
  v_accvgpr_read_b32 v55, a111
  v_cvt_pk_bf16_f32 v16, v40, v41
  v_cvt_pk_bf16_f32 v20, v48, v49
  v_cvt_pk_bf16_f32 v17, v42, v43
  v_cvt_pk_bf16_f32 v21, v50, v51
  v_cvt_pk_bf16_f32 v18, v44, v45
  v_cvt_pk_bf16_f32 v22, v52, v53
  v_cvt_pk_bf16_f32 v19, v46, v47
  v_cvt_pk_bf16_f32 v23, v54, v55
  s_swappc_b64 s[56:57], s[58:59]
  v_mfma_f32_32x32x16_bf16 v[40:55], v[24:27], v[104:107], 0
  v_mfma_f32_32x32x16_bf16 v[56:71], v[32:35], v[104:107], 0
  v_mfma_f32_32x32x16_bf16 v[40:55], v[28:31], v[108:111], v[40:55]
  v_mfma_f32_32x32x16_bf16 v[56:71], v[36:39], v[108:111], v[56:71]
  v_accvgpr_read_b32 v72, a112
  v_accvgpr_read_b32 v73, a113
  v_accvgpr_read_b32 v74, a114
  v_accvgpr_read_b32 v75, a115
  v_accvgpr_read_b32 v76, a116
  v_accvgpr_read_b32 v77, a117
  v_accvgpr_read_b32 v78, a118
  v_accvgpr_read_b32 v79, a119
  v_accvgpr_read_b32 v80, a120
  v_accvgpr_read_b32 v81, a121
  v_accvgpr_read_b32 v82, a122
  v_accvgpr_read_b32 v83, a123
  v_accvgpr_read_b32 v84, a124
  v_accvgpr_read_b32 v85, a125
  v_accvgpr_read_b32 v86, a126
  v_accvgpr_read_b32 v87, a127
  v_cvt_pk_bf16_f32 v16, v72, v73
  v_cvt_pk_bf16_f32 v17, v74, v75
  v_cvt_pk_bf16_f32 v18, v76, v77
  v_cvt_pk_bf16_f32 v19, v78, v79
  v_cvt_pk_bf16_f32 v20, v80, v81
  v_cvt_pk_bf16_f32 v21, v82, v83
  v_cvt_pk_bf16_f32 v22, v84, v85
  v_cvt_pk_bf16_f32 v23, v86, v87
  s_mov_b32 s4, 0x3f803f80
  v_mov_b32 v5, s4
  v_cndmask_b32 v112, v5, v16, s[54:55]
  v_cndmask_b32 v120, v16, v5, s[54:55]
  v_cndmask_b32 v113, v5, v17, s[54:55]
  v_cndmask_b32 v121, v17, v5, s[54:55]
  v_cndmask_b32 v114, v5, v18, s[54:55]
  v_cndmask_b32 v122, v18, v5, s[54:55]
  v_cndmask_b32 v115, v5, v19, s[54:55]
  v_cndmask_b32 v123, v19, v5, s[54:55]
  v_cndmask_b32 v116, v5, v20, s[54:55]
  v_cndmask_b32 v124, v20, v5, s[54:55]
  v_cndmask_b32 v117, v5, v21, s[54:55]
  v_cndmask_b32 v125, v21, v5, s[54:55]
  v_cndmask_b32 v118, v5, v22, s[54:55]
  v_cndmask_b32 v126, v22, v5, s[54:55]
  v_cndmask_b32 v119, v5, v23, s[54:55]
  v_cndmask_b32 v127, v23, v5, s[54:55]
  v_cvt_pk_bf16_f32 v24, v40, v41
  v_cvt_pk_bf16_f32 v25, v42, v43
  v_cvt_pk_bf16_f32 v26, v44, v45
  v_cvt_pk_bf16_f32 v27, v46, v47
  v_cvt_pk_bf16_f32 v28, v48, v49
  v_cvt_pk_bf16_f32 v29, v50, v51
  v_cvt_pk_bf16_f32 v30, v52, v53
  v_cvt_pk_bf16_f32 v31, v54, v55
  v_cvt_pk_bf16_f32 v32, v56, v57
  v_cvt_pk_bf16_f32 v33, v58, v59
  v_cvt_pk_bf16_f32 v34, v60, v61
  v_cvt_pk_bf16_f32 v35, v62, v63
  v_cvt_pk_bf16_f32 v36, v64, v65
  v_cvt_pk_bf16_f32 v37, v66, v67
  v_cvt_pk_bf16_f32 v38, v68, v69
  v_cvt_pk_bf16_f32 v39, v70, v71
  v_mfma_f32_32x32x16_bf16 v[40:55], v[24:27], v[112:115], 0
  v_mfma_f32_32x32x16_bf16 v[56:71], v[32:35], v[120:123], 0
  v_mfma_f32_32x32x16_bf16 v[40:55], v[28:31], v[116:119], v[40:55]
  v_mfma_f32_32x32x16_bf16 v[56:71], v[36:39], v[124:127], v[56:71]
  s_mul_i32 s4, s79, 4352
  s_add_u32 s4, s4, 131072
  v_lshlrev_b32 v5, 4, v1
  v_add_u32 v5, s4, v5
  v_lshlrev_b32 v6, 4, v3
  v_add_u32 v6, s4, v6
  s_nop 5
  v_cndmask_b32 v72, v56, v40, s[54:55]
  v_cndmask_b32 v73, v57, v41, s[54:55]
  v_cndmask_b32 v74, v58, v42, s[54:55]
  v_cndmask_b32 v75, v59, v43, s[54:55]
  v_cndmask_b32 v76, v60, v44, s[54:55]
  v_cndmask_b32 v77, v61, v45, s[54:55]
  v_cndmask_b32 v78, v62, v46, s[54:55]
  v_cndmask_b32 v79, v63, v47, s[54:55]
  v_cndmask_b32 v80, v64, v48, s[54:55]
  v_cndmask_b32 v81, v65, v49, s[54:55]
  v_cndmask_b32 v82, v66, v50, s[54:55]
  v_cndmask_b32 v83, v67, v51, s[54:55]
  v_cndmask_b32 v84, v68, v52, s[54:55]
  v_cndmask_b32 v85, v69, v53, s[54:55]
  v_cndmask_b32 v86, v70, v54, s[54:55]
  v_cndmask_b32 v87, v71, v55, s[54:55]
  ds_write_b128 v5, v[72:75] offset:0
  ds_write_b128 v5, v[76:79] offset:1024
  ds_write_b128 v5, v[80:83] offset:2048
  ds_write_b128 v5, v[84:87] offset:3072
  s_mov_b32 s6, 0x10000
  s_mov_b32 s7, 0x10000
  s_mov_b64 exec, s[6:7]
  ds_write_b128 v6, v[40:43] offset:4096
  ds_write_b128 v6, v[44:47] offset:4128
  ds_write_b128 v6, v[48:51] offset:4160
  ds_write_b128 v6, v[52:55] offset:4192
  s_mov_b32 s6, 1
  s_mov_b32 s7, 1
  s_mov_b64 exec, s[6:7]
  ds_write_b128 v6, v[56:59] offset:4224
  ds_write_b128 v6, v[60:63] offset:4256
  ds_write_b128 v6, v[64:67] offset:4288
  ds_write_b128 v6, v[68:71] offset:4320
  s_mov_b64 exec, -1
  s_waitcnt lgkmcnt(0)
  v_mov_b32 v5, 162824
  v_mov_b32 v6, 1
  s_mov_b64 exec, 1
  ds_add_u32 v5, v6
  s_mov_b64 exec, -1
  v_mov_b32 v5, 162824
  s_mov_b32 s7, 1048576
L_ls_8:
  ds_read_b32 v6, v5
  s_waitcnt lgkmcnt(0)
  v_readfirstlane_b32 s4, v6
  s_nop 3
  s_cmp_ge_u32 s4, 4
  s_cbranch_scc1 L_lo_9
  s_sub_u32 s7, s7, 1
  s_cmp_eq_u32 s7, 0
  s_cbranch_scc1 L_lo_9
  s_sleep 1
  s_branch L_ls_8
L_lo_9:
  v_and_b32 v4, 255, v0
  v_lshlrev_b32 v4, 2, v4
  v_add_u32 v6, 131072, v4
  ds_read_b32 v112, v6 offset:0
  ds_read_b32 v120, v6 offset:4352
  ds_read_b32 v113, v6 offset:1024
  ds_read_b32 v121, v6 offset:5376
  ds_read_b32 v114, v6 offset:2048
  ds_read_b32 v122, v6 offset:6400
  ds_read_b32 v115, v6 offset:3072
  ds_read_b32 v123, v6 offset:7424
  ds_read_b32 v116, v6 offset:8704
  ds_read_b32 v124, v6 offset:13056
  ds_read_b32 v117, v6 offset:9728
  ds_read_b32 v125, v6 offset:14080
  ds_read_b32 v118, v6 offset:10752
  ds_read_b32 v126, v6 offset:15104
  ds_read_b32 v119, v6 offset:11776
  ds_read_b32 v127, v6 offset:16128
  s_and_b32 s5, s79, 1
  s_mul_i32 s6, s5, 8704
  s_add_u32 s6, s6, 135168
  v_lshlrev_b32 v7, 2, v1
  v_add_u32 v90, s6, v7
  ds_read_b32 v88, v90
  ds_read_b32 v89, v90 offset:4352
  s_waitcnt lgkmcnt(0)
  v_add_f32 v112, v112, v120
  v_add_f32 v113, v113, v121
  v_add_f32 v114, v114, v122
  v_add_f32 v115, v115, v123
  v_add_f32 v116, v116, v124
  v_add_f32 v117, v117, v125
  v_add_f32 v118, v118, v126
  v_add_f32 v119, v119, v127
  v_add_f32 v88, v88, v89
  v_mov_b32 v91, v7
  v_mov_b32 v5, 162836
  s_mov_b32 s7, 1048576
L_ls_10:
  ds_read_b32 v6, v5
  s_waitcnt lgkmcnt(0)
  v_readfirstlane_b32 s4, v6
  s_nop 3
  s_cmp_ge_u32 s4, 1
  s_cbranch_scc1 L_lo_11
  s_sub_u32 s7, s7, 1
  s_cmp_eq_u32 s7, 0
  s_cbranch_scc1 L_lo_11
  s_sleep 1
  s_branch L_ls_10
L_lo_11:
  s_lshl_b32 s4, s84, 1
  s_mul_i32 s4, s4, 4352
  s_add_u32 s4, s4, 6291456
  s_add_u32 s5, s4, 4352
  buffer_atomic_add_f32 v112, v4, s[28:31], s4 offen offset:0
  buffer_atomic_add_f32 v113, v4, s[28:31], s4 offen offset:1024
  buffer_atomic_add_f32 v114, v4, s[28:31], s4 offen offset:2048
  buffer_atomic_add_f32 v115, v4, s[28:31], s4 offen offset:3072
  buffer_atomic_add_f32 v116, v4, s[28:31], s5 offen offset:0
  buffer_atomic_add_f32 v117, v4, s[28:31], s5 offen offset:1024
  buffer_atomic_add_f32 v118, v4, s[28:31], s5 offen offset:2048
  buffer_atomic_add_f32 v119, v4, s[28:31], s5 offen offset:3072
  s_cmp_ge_u32 s79, 2
  s_cbranch_scc1 L_zat_12
  s_mul_i32 s6, s79, 4352
  s_add_u32 s6, s6, s4
  s_add_u32 s6, s6, 4096
  buffer_atomic_add_f32 v88, v91, s[28:31], s6 offen
L_zat_12:
  s_cmp_eq_u32 s85, 1
  s_cbranch_scc1 L_c_q
  s_cmp_eq_u32 s85, 2
  s_cbranch_scc1 L_c_i
  s_branch L_c_b1
L_c_q:
  s_lshl_b32 s62, s87, 2
  s_add_u32 s62, s62, s79
  v_lshrrev_b32 v5, 4, v2
  v_lshlrev_b32 v5, 9, v5
  v_and_b32 v6, 15, v2
  v_lshl_add_u32 v5, v6, 1, v5
  v_lshl_add_u32 v5, v3, 7, v5
  s_lshl_b32 s4, s62, 10
  buffer_load_ushort v112, v5, s[36:39], s4 offen offset:0
  buffer_load_ushort v113, v5, s[36:39], s4 offen offset:32
  buffer_load_ushort v114, v5, s[36:39], s4 offen offset:64
  buffer_load_ushort v115, v5, s[36:39], s4 offen offset:96
  buffer_load_ushort v116, v5, s[36:39], s4 offen offset:256
  buffer_load_ushort v117, v5, s[36:39], s4 offen offset:288
  buffer_load_ushort v118, v5, s[36:39], s4 offen offset:320
  buffer_load_ushort v119, v5, s[36:39], s4 offen offset:352
  s_and_b32 s6, s79, 1
  s_lshl_b32 s6, s6, 6
  v_bfe_u32 v5, v1, 2, 2
  v_lshl_add_u32 v6, v3, 3, v5
  v_lshlrev_b32 v6, 7, v6
  v_lshrrev_b32 v5, 1, v5
  v_lshlrev_b32 v5, 6, v5
  v_xor_b32 v5, s6, v5
  v_add_u32 v6, v6, v5
  v_bfe_u32 v5, v1, 4, 1
  v_lshl_add_u32 v6, v5, 5, v6
  v_and_b32 v5, 3, v1
  v_lshl_add_u32 v10, v5, 3, v6
  v_add_u32 v11, 65536, v10
  s_lshr_b32 s4, s79, 1
  s_lshl_b32 s4, s4, 14
  s_add_u32 s4, s4, 8192
  v_add_u32 v10, s4, v10
  v_add_u32 v11, s4, v11
  v_lshlrev_b32 v5, 7, v2
  v_bfe_u32 v6, v2, 1, 3
  v_xor_b32 v6, v6, v3
  v_lshl_add_u32 v5, v6, 4, v5
  v_xor_b32 v104, 0, v5
  v_add_u32 v105, 65536, v104
  v_xor_b32 v106, 32, v5
  v_add_u32 v107, 65536, v106
  v_xor_b32 v108, 64, v5
  v_add_u32 v109, 65536, v108
  v_xor_b32 v110, 96, v5
  v_add_u32 v111, 65536, v110
  s_waitcnt lgkmcnt(0)
  s_barrier
  ds_read_b64_tr_b16 a[64:65], v11 offset:32768
  ds_read_b64_tr_b16 a[66:67], v11 offset:33280
  ds_read_b128 a[68:71], v105 offset:32768
  ds_read_b128 a[72:75], v105 offset:36864
  ds_read_b128 a[76:79], v105 offset:49152
  ds_read_b128 a[80:83], v105 offset:53248
  ds_read_b64_tr_b16 a[84:85], v11 offset:34816
  ds_read_b64_tr_b16 a[86:87], v11 offset:35328
  ds_read_b128 a[88:91], v107 offset:32768
  ds_read_b128 a[92:95], v107 offset:36864
  ds_read_b128 a[96:99], v107 offset:49152
  ds_read_b128 a[100:103], v107 offset:53248
  s_waitcnt lgkmcnt(6)
  v_mfma_f32_32x32x16_bf16 a[0:15], a[64:67], a[68:71], 0
  ds_read_b64_tr_b16 a[104:105], v11 offset:36864
  v_mfma_f32_32x32x16_bf16 a[16:31], a[64:67], a[72:75], 0
  ds_read_b64_tr_b16 a[106:107], v11 offset:37376
  ds_read_b128 a[108:111], v109 offset:32768
  v_mfma_f32_32x32x16_bf16 a[32:47], a[64:67], a[76:79], 0
  ds_read_b128 a[112:115], v109 offset:36864
  v_mfma_f32_32x32x16_bf16 a[48:63], a[64:67], a[80:83], 0
  ds_read_b128 a[116:119], v109 offset:49152
  ds_read_b128 a[120:123], v109 offset:53248
  s_waitcnt lgkmcnt(6)
  v_mfma_f32_32x32x16_bf16 a[0:15], a[84:87], a[88:91], a[0:15]
  ds_read_b64_tr_b16 a[64:65], v11 offset:38912
  v_mfma_f32_32x32x16_bf16 a[16:31], a[84:87], a[92:95], a[16:31]
  ds_read_b64_tr_b16 a[66:67], v11 offset:39424
  ds_read_b128 a[68:71], v111 offset:32768
  v_mfma_f32_32x32x16_bf16 a[32:47], a[84:87], a[96:99], a[32:47]
  ds_read_b128 a[72:75], v111 offset:36864
  v_mfma_f32_32x32x16_bf16 a[48:63], a[84:87], a[100:103], a[48:63]
  ds_read_b128 a[76:79], v111 offset:49152
  ds_read_b128 a[80:83], v111 offset:53248
  s_waitcnt lgkmcnt(0)
  s_barrier
  v_mfma_f32_32x32x16_bf16 a[0:15], a[104:107], a[108:111], a[0:15]
  ds_read_b64_tr_b16 a[84:85], v10 offset:0
  v_mfma_f32_32x32x16_bf16 a[16:31], a[104:107], a[112:115], a[16:31]
  ds_read_b64_tr_b16 a[86:87], v10 offset:512
  ds_read_b128 a[88:91], v104 offset:0
  v_mfma_f32_32x32x16_bf16 a[32:47], a[104:107], a[116:119], a[32:47]
  ds_read_b128 a[92:95], v104 offset:4096
  v_mfma_f32_32x32x16_bf16 a[48:63], a[104:107], a[120:123], a[48:63]
  ds_read_b128 a[96:99], v104 offset:16384
  ds_read_b128 a[100:103], v104 offset:20480
  v_mfma_f32_32x32x16_bf16 a[0:15], a[64:67], a[68:71], a[0:15]
  ds_read_b64_tr_b16 a[104:105], v10 offset:2048
  v_mfma_f32_32x32x16_bf16 a[16:31], a[64:67], a[72:75], a[16:31]
  ds_read_b64_tr_b16 a[106:107], v10 offset:2560
  ds_read_b128 a[108:111], v106 offset:0
  v_mfma_f32_32x32x16_bf16 a[32:47], a[64:67], a[76:79], a[32:47]
  ds_read_b128 a[112:115], v106 offset:4096
  v_mfma_f32_32x32x16_bf16 a[48:63], a[64:67], a[80:83], a[48:63]
  ds_read_b128 a[116:119], v106 offset:16384
  ds_read_b128 a[120:123], v106 offset:20480
  s_waitcnt lgkmcnt(6)
  v_mfma_f32_32x32x16_bf16 a[0:15], a[84:87], a[88:91], a[0:15]
  ds_read_b64_tr_b16 a[64:65], v10 offset:4096
  v_mfma_f32_32x32x16_bf16 a[16:31], a[84:87], a[92:95], a[16:31]
  ds_read_b64_tr_b16 a[66:67], v10 offset:4608
  ds_read_b128 a[68:71], v108 offset:0
  v_mfma_f32_32x32x16_bf16 a[32:47], a[84:87], a[96:99], a[32:47]
  ds_read_b128 a[72:75], v108 offset:4096
  v_mfma_f32_32x32x16_bf16 a[48:63], a[84:87], a[100:103], a[48:63]
  ds_read_b128 a[76:79], v108 offset:16384
  ds_read_b128 a[80:83], v108 offset:20480
  s_waitcnt lgkmcnt(6)
  v_mfma_f32_32x32x16_bf16 a[0:15], a[104:107], a[108:111], a[0:15]
  ds_read_b64_tr_b16 a[84:85], v10 offset:6144
  v_mfma_f32_32x32x16_bf16 a[16:31], a[104:107], a[112:115], a[16:31]
  ds_read_b64_tr_b16 a[86:87], v10 offset:6656
  ds_read_b128 a[88:91], v110 offset:0
  v_mfma_f32_32x32x16_bf16 a[32:47], a[104:107], a[116:119], a[32:47]
  ds_read_b128 a[92:95], v110 offset:4096
  v_mfma_f32_32x32x16_bf16 a[48:63], a[104:107], a[120:123], a[48:63]
  ds_read_b128 a[96:99], v110 offset:16384
  ds_read_b128 a[100:103], v110 offset:20480
  s_waitcnt lgkmcnt(0)
  s_barrier
  v_mfma_f32_32x32x16_bf16 a[0:15], a[64:67], a[68:71], a[0:15]
  ds_read_b64_tr_b16 a[104:105], v10 offset:32768
  v_mfma_f32_32x32x16_bf16 a[16:31], a[64:67], a[72:75], a[16:31]
  ds_read_b64_tr_b16 a[106:107], v10 offset:33280
  ds_read_b128 a[108:111], v104 offset:32768
  v_mfma_f32_32x32x16_bf16 a[32:47], a[64:67], a[76:79], a[32:47]
  ds_read_b128 a[112:115], v104 offset:36864
  v_mfma_f32_32x32x16_bf16 a[48:63], a[64:67], a[80:83], a[48:63]
  ds_read_b128 a[116:119], v104 offset:49152
  ds_read_b128 a[120:123], v104 offset:53248
  v_mfma_f32_32x32x16_bf16 a[0:15], a[84:87], a[88:91], a[0:15]
  ds_read_b64_tr_b16 a[64:65], v10 offset:34816
  v_mfma_f32_32x32x16_bf16 a[16:31], a[84:87], a[92:95], a[16:31]
  ds_read_b64_tr_b16 a[66:67], v10 offset:35328
  ds_read_b128 a[68:71], v106 offset:32768
  v_mfma_f32_32x32x16_bf16 a[32:47], a[84:87], a[96:99], a[32:47]
  ds_read_b128 a[72:75], v106 offset:36864
  v_mfma_f32_32x32x16_bf16 a[48:63], a[84:87], a[100:103], a[48:63]
  ds_read_b128 a[76:79], v106 offset:49152
  ds_read_b128 a[80:83], v106 offset:53248
  s_waitcnt lgkmcnt(6)
  v_mfma_f32_32x32x16_bf16 a[0:15], a[104:107], a[108:111], a[0:15]
  ds_read_b64_tr_b16 a[84:85], v10 offset:36864
  v_mfma_f32_32x32x16_bf16 a[16:31], a[104:107], a[112:115], a[16:31]
  ds_read_b64_tr_b16 a[86:87], v10 offset:37376
  ds_read_b128 a[88:91], v108 offset:32768
  v_mfma_f32_32x32x16_bf16 a[32:47], a[104:107], a[116:119], a[32:47]
  ds_read_b128 a[92:95], v108 offset:36864
  v_mfma_f32_32x32x16_bf16 a[48:63], a[104:107], a[120:123], a[48:63]
  ds_read_b128 a[96:99], v108 offset:49152
  ds_read_b128 a[100:103], v108 offset:53248
  s_waitcnt lgkmcnt(6)
  v_mfma_f32_32x32x16_bf16 a[0:15], a[64:67], a[68:71], a[0:15]
  ds_read_b64_tr_b16 a[104:105], v10 offset:38912
  v_mfma_f32_32x32x16_bf16 a[16:31], a[64:67], a[72:75], a[16:31]
  ds_read_b64_tr_b16 a[106:107], v10 offset:39424
  ds_read_b128 a[108:111], v110 offset:32768
  v_mfma_f32_32x32x16_bf16 a[32:47], a[64:67], a[76:79], a[32:47]
  ds_read_b128 a[112:115], v110 offset:36864
  v_mfma_f32_32x32x16_bf16 a[48:63], a[64:67], a[80:83], a[48:63]
  ds_read_b128 a[116:119], v110 offset:49152
  ds_read_b128 a[120:123], v110 offset:53248
  s_waitcnt lgkmcnt(0)
  s_barrier
  v_mfma_f32_32x32x16_bf16 a[0:15], a[84:87], a[88:91], a[0:15]
  ds_read_b64_tr_b16 a[64:65], v11 offset:0
  v_mfma_f32_32x32x16_bf16 a[16:31], a[84:87], a[92:95], a[16:31]
  ds_read_b64_tr_b16 a[66:67], v11 offset:512
  ds_read_b128 a[68:71], v105 offset:0
  v_mfma_f32_32x32x16_bf16 a[32:47], a[84:87], a[96:99], a[32:47]
  ds_read_b128 a[72:75], v105 offset:4096
  v_mfma_f32_32x32x16_bf16 a[48:63], a[84:87], a[100:103], a[48:63]
  ds_read_b128 a[76:79], v105 offset:16384
  ds_read_b128 a[80:83], v105 offset:20480
  v_mfma_f32_32x32x16_bf16 a[0:15], a[104:107], a[108:111], a[0:15]
  ds_read_b64_tr_b16 a[84:85], v11 offset:2048
  v_mfma_f32_32x32x16_bf16 a[16:31], a[104:107], a[112:115], a[16:31]
  ds_read_b64_tr_b16 a[86:87], v11 offset:2560
  ds_read_b128 a[88:91], v107 offset:0
  v_mfma_f32_32x32x16_bf16 a[32:47], a[104:107], a[116:119], a[32:47]
  ds_read_b128 a[92:95], v107 offset:4096
  v_mfma_f32_32x32x16_bf16 a[48:63], a[104:107], a[120:123], a[48:63]
  ds_read_b128 a[96:99], v107 offset:16384
  ds_read_b128 a[100:103], v107 offset:20480
  s_waitcnt lgkmcnt(6)
  v_mfma_f32_32x32x16_bf16 a[0:15], a[64:67], a[68:71], a[0:15]
  ds_read_b64_tr_b16 a[104:105], v11 offset:4096
  v_mfma_f32_32x32x16_bf16 a[16:31], a[64:67], a[72:75], a[16:31]
  ds_read_b64_tr_b16 a[106:107], v11 offset:4608
  ds_read_b128 a[108:111], v109 offset:0
  v_mfma_f32_32x32x16_bf16 a[32:47], a[64:67], a[76:79], a[32:47]
  ds_read_b128 a[112:115], v109 offset:4096
  v_mfma_f32_32x32x16_bf16 a[48:63], a[64:67], a[80:83], a[48:63]
  ds_read_b128 a[116:119], v109 offset:16384
  ds_read_b128 a[120:123], v109 offset:20480
  s_waitcnt lgkmcnt(6)
  v_mfma_f32_32x32x16_bf16 a[0:15], a[84:87], a[88:91], a[0:15]
  ds_read_b64_tr_b16 a[64:65], v11 offset:6144
  v_mfma_f32_32x32x16_bf16 a[16:31], a[84:87], a[92:95], a[16:31]
  ds_read_b64_tr_b16 a[66:67], v11 offset:6656
  ds_read_b128 a[68:71], v111 offset:0
  v_mfma_f32_32x32x16_bf16 a[32:47], a[84:87], a[96:99], a[32:47]
  ds_read_b128 a[72:75], v111 offset:4096
  v_mfma_f32_32x32x16_bf16 a[48:63], a[84:87], a[100:103], a[48:63]
  ds_read_b128 a[76:79], v111 offset:16384
  ds_read_b128 a[80:83], v111 offset:20480
  s_waitcnt lgkmcnt(0)
  s_barrier
  s_waitcnt vmcnt(8)
  v_mov_b32 v5, 162828
  v_mov_b32 v6, 1
  s_mov_b64 exec, 1
  ds_add_rtn_u32 v7, v5, v6
  s_waitcnt lgkmcnt(0)
  v_readfirstlane_b32 s4, v7
  s_nop 3
  s_cmp_lg_u32 s4, 3
  s_cbranch_scc1 L_el_15
  v_mov_b32 v5, s93
  buffer_store_dword v6, v5, s[28:31], 0 offen sc1
L_el_15:
  s_mov_b64 exec, -1
  v_mfma_f32_32x32x16_bf16 a[0:15], a[104:107], a[108:111], a[0:15]
  ds_read_b64_tr_b16 a[84:85], v11 offset:32768
  v_mfma_f32_32x32x16_bf16 a[16:31], a[104:107], a[112:115], a[16:31]
  ds_read_b64_tr_b16 a[86:87], v11 offset:33280
  ds_read_b128 a[88:91], v105 offset:32768
  v_mfma_f32_32x32x16_bf16 a[32:47], a[104:107], a[116:119], a[32:47]
  ds_read_b128 a[92:95], v105 offset:36864
  v_mfma_f32_32x32x16_bf16 a[48:63], a[104:107], a[120:123], a[48:63]
  ds_read_b128 a[96:99], v105 offset:49152
  ds_read_b128 a[100:103], v105 offset:53248
  v_mfma_f32_32x32x16_bf16 a[0:15], a[64:67], a[68:71], a[0:15]
  ds_read_b64_tr_b16 a[104:105], v11 offset:34816
  v_mfma_f32_32x32x16_bf16 a[16:31], a[64:67], a[72:75], a[16:31]
  ds_read_b64_tr_b16 a[106:107], v11 offset:35328
  ds_read_b128 a[108:111], v107 offset:32768
  v_mfma_f32_32x32x16_bf16 a[32:47], a[64:67], a[76:79], a[32:47]
  ds_read_b128 a[112:115], v107 offset:36864
  v_mfma_f32_32x32x16_bf16 a[48:63], a[64:67], a[80:83], a[48:63]
  ds_read_b128 a[116:119], v107 offset:49152
  ds_read_b128 a[120:123], v107 offset:53248
  s_waitcnt lgkmcnt(6)
  v_mfma_f32_32x32x16_bf16 a[0:15], a[84:87], a[88:91], a[0:15]
  ds_read_b64_tr_b16 a[64:65], v11 offset:36864
  v_mfma_f32_32x32x16_bf16 a[16:31], a[84:87], a[92:95], a[16:31]
  ds_read_b64_tr_b16 a[66:67], v11 offset:37376
  ds_read_b128 a[68:71], v109 offset:32768
  v_mfma_f32_32x32x16_bf16 a[32:47], a[84:87], a[96:99], a[32:47]
  ds_read_b128 a[72:75], v109 offset:36864
  v_mfma_f32_32x32x16_bf16 a[48:63], a[84:87], a[100:103], a[48:63]
  ds_read_b128 a[76:79], v109 offset:49152
  ds_read_b128 a[80:83], v109 offset:53248
  s_waitcnt lgkmcnt(6)
  v_mfma_f32_32x32x16_bf16 a[0:15], a[104:107], a[108:111], a[0:15]
  ds_read_b64_tr_b16 a[84:85], v11 offset:38912
  v_mfma_f32_32x32x16_bf16 a[16:31], a[104:107], a[112:115], a[16:31]
  ds_read_b64_tr_b16 a[86:87], v11 offset:39424
  ds_read_b128 a[88:91], v111 offset:32768
  v_mfma_f32_32x32x16_bf16 a[32:47], a[104:107], a[116:119], a[32:47]
  ds_read_b128 a[92:95], v111 offset:36864
  v_mfma_f32_32x32x16_bf16 a[48:63], a[104:107], a[120:123], a[48:63]
  ds_read_b128 a[96:99], v111 offset:49152
  ds_read_b128 a[100:103], v111 offset:53248
  s_waitcnt lgkmcnt(0)
  s_barrier
  v_mfma_f32_32x32x16_bf16 a[0:15], a[64:67], a[68:71], a[0:15]
  ds_read_b64_tr_b16 a[104:105], v10 offset:0
  v_mfma_f32_32x32x16_bf16 a[16:31], a[64:67], a[72:75], a[16:31]
  ds_read_b64_tr_b16 a[106:107], v10 offset:512
  ds_read_b128 a[108:111], v104 offset:0
  v_mfma_f32_32x32x16_bf16 a[32:47], a[64:67], a[76:79], a[32:47]
  ds_read_b128 a[112:115], v104 offset:4096
  v_mfma_f32_32x32x16_bf16 a[48:63], a[64:67], a[80:83], a[48:63]
  ds_read_b128 a[116:119], v104 offset:16384
  ds_read_b128 a[120:123], v104 offset:20480
  v_mfma_f32_32x32x16_bf16 a[0:15], a[84:87], a[88:91], a[0:15]
  ds_read_b64_tr_b16 a[64:65], v10 offset:2048
  v_mfma_f32_32x32x16_bf16 a[16:31], a[84:87], a[92:95], a[16:31]
  ds_read_b64_tr_b16 a[66:67], v10 offset:2560
  ds_read_b128 a[68:71], v106 offset:0
  v_mfma_f32_32x32x16_bf16 a[32:47], a[84:87], a[96:99], a[32:47]
  ds_read_b128 a[72:75], v106 offset:4096
  v_mfma_f32_32x32x16_bf16 a[48:63], a[84:87], a[100:103], a[48:63]
  ds_read_b128 a[76:79], v106 offset:16384
  ds_read_b128 a[80:83], v106 offset:20480
  s_waitcnt lgkmcnt(6)
  v_mfma_f32_32x32x16_bf16 a[0:15], a[104:107], a[108:111], a[0:15]
  ds_read_b64_tr_b16 a[84:85], v10 offset:4096
  v_mfma_f32_32x32x16_bf16 a[16:31], a[104:107], a[112:115], a[16:31]
  ds_read_b64_tr_b16 a[86:87], v10 offset:4608
  ds_read_b128 a[88:91], v108 offset:0
  v_mfma_f32_32x32x16_bf16 a[32:47], a[104:107], a[116:119], a[32:47]
  ds_read_b128 a[92:95], v108 offset:4096
  v_mfma_f32_32x32x16_bf16 a[48:63], a[104:107], a[120:123], a[48:63]
  ds_read_b128 a[96:99], v108 offset:16384
  ds_read_b128 a[100:103], v108 offset:20480
  s_waitcnt lgkmcnt(6)
  v_mfma_f32_32x32x16_bf16 a[0:15], a[64:67], a[68:71], a[0:15]
  ds_read_b64_tr_b16 a[104:105], v10 offset:6144
  v_mfma_f32_32x32x16_bf16 a[16:31], a[64:67], a[72:75], a[16:31]
  ds_read_b64_tr_b16 a[106:107], v10 offset:6656
  ds_read_b128 a[108:111], v110 offset:0
  v_mfma_f32_32x32x16_bf16 a[32:47], a[64:67], a[76:79], a[32:47]
  ds_read_b128 a[112:115], v110 offset:4096
  v_mfma_f32_32x32x16_bf16 a[48:63], a[64:67], a[80:83], a[48:63]
  ds_read_b128 a[116:119], v110 offset:16384
  ds_read_b128 a[120:123], v110 offset:20480
  s_waitcnt lgkmcnt(0)
  s_barrier
  v_mfma_f32_32x32x16_bf16 a[0:15], a[84:87], a[88:91], a[0:15]
  ds_read_b64_tr_b16 a[64:65], v10 offset:32768
  v_mfma_f32_32x32x16_bf16 a[16:31], a[84:87], a[92:95], a[16:31]
  ds_read_b64_tr_b16 a[66:67], v10 offset:33280
  ds_read_b128 a[68:71], v104 offset:32768
  v_mfma_f32_32x32x16_bf16 a[32:47], a[84:87], a[96:99], a[32:47]
  ds_read_b128 a[72:75], v104 offset:36864
  v_mfma_f32_32x32x16_bf16 a[48:63], a[84:87], a[100:103], a[48:63]
  ds_read_b128 a[76:79], v104 offset:49152
  ds_read_b128 a[80:83], v104 offset:53248
  v_mfma_f32_32x32x16_bf16 a[0:15], a[104:107], a[108:111], a[0:15]
  ds_read_b64_tr_b16 a[84:85], v10 offset:34816
  v_mfma_f32_32x32x16_bf16 a[16:31], a[104:107], a[112:115], a[16:31]
  ds_read_b64_tr_b16 a[86:87], v10 offset:35328
  ds_read_b128 a[88:91], v106 offset:32768
  v_mfma_f32_32x32x16_bf16 a[32:47], a[104:107], a[116:119], a[32:47]
  ds_read_b128 a[92:95], v106 offset:36864
  v_mfma_f32_32x32x16_bf16 a[48:63], a[104:107], a[120:123], a[48:63]
  ds_read_b128 a[96:99], v106 offset:49152
  ds_read_b128 a[100:103], v106 offset:53248
  s_waitcnt lgkmcnt(6)
  v_mfma_f32_32x32x16_bf16 a[0:15], a[64:67], a[68:71], a[0:15]
  ds_read_b64_tr_b16 a[104:105], v10 offset:36864
  v_mfma_f32_32x32x16_bf16 a[16:31], a[64:67], a[72:75], a[16:31]
  ds_read_b64_tr_b16 a[106:107], v10 offset:37376
  ds_read_b128 a[108:111], v108 offset:32768
  v_mfma_f32_32x32x16_bf16 a[32:47], a[64:67], a[76:79], a[32:47]
  ds_read_b128 a[112:115], v108 offset:36864
  v_mfma_f32_32x32x16_bf16 a[48:63], a[64:67], a[80:83], a[48:63]
  ds_read_b128 a[116:119], v108 offset:49152
  ds_read_b128 a[120:123], v108 offset:53248
  s_waitcnt lgkmcnt(6)
  v_mfma_f32_32x32x16_bf16 a[0:15], a[84:87], a[88:91], a[0:15]
  ds_read_b64_tr_b16 a[64:65], v10 offset:38912
  v_mfma_f32_32x32x16_bf16 a[16:31], a[84:87], a[92:95], a[16:31]
  ds_read_b64_tr_b16 a[66:67], v10 offset:39424
  ds_read_b128 a[68:71], v110 offset:32768
  v_mfma_f32_32x32x16_bf16 a[32:47], a[84:87], a[96:99], a[32:47]
  ds_read_b128 a[72:75], v110 offset:36864
  v_mfma_f32_32x32x16_bf16 a[48:63], a[84:87], a[100:103], a[48:63]
  ds_read_b128 a[76:79], v110 offset:49152
  ds_read_b128 a[80:83], v110 offset:53248
  s_waitcnt lgkmcnt(0)
  s_barrier
  v_mfma_f32_32x32x16_bf16 a[0:15], a[104:107], a[108:111], a[0:15]
  ds_read_b64_tr_b16 a[84:85], v11 offset:0
  v_mfma_f32_32x32x16_bf16 a[16:31], a[104:107], a[112:115], a[16:31]
  ds_read_b64_tr_b16 a[86:87], v11 offset:512
  ds_read_b128 a[88:91], v105 offset:0
  v_mfma_f32_32x32x16_bf16 a[32:47], a[104:107], a[116:119], a[32:47]
  ds_read_b128 a[92:95], v105 offset:4096
  v_mfma_f32_32x32x16_bf16 a[48:63], a[104:107], a[120:123], a[48:63]
  ds_read_b128 a[96:99], v105 offset:16384
  ds_read_b128 a[100:103], v105 offset:20480
  v_mfma_f32_32x32x16_bf16 a[0:15], a[64:67], a[68:71], a[0:15]
  ds_read_b64_tr_b16 a[104:105], v11 offset:2048
  v_mfma_f32_32x32x16_bf16 a[16:31], a[64:67], a[72:75], a[16:31]
  ds_read_b64_tr_b16 a[106:107], v11 offset:2560
  ds_read_b128 a[108:111], v107 offset:0
  v_mfma_f32_32x32x16_bf16 a[32:47], a[64:67], a[76:79], a[32:47]
  ds_read_b128 a[112:115], v107 offset:4096
  v_mfma_f32_32x32x16_bf16 a[48:63], a[64:67], a[80:83], a[48:63]
  ds_read_b128 a[116:119], v107 offset:16384
  ds_read_b128 a[120:123], v107 offset:20480
  s_waitcnt lgkmcnt(6)
  v_mfma_f32_32x32x16_bf16 a[0:15], a[84:87], a[88:91], a[0:15]
  ds_read_b64_tr_b16 a[64:65], v11 offset:4096
  v_mfma_f32_32x32x16_bf16 a[16:31], a[84:87], a[92:95], a[16:31]
  ds_read_b64_tr_b16 a[66:67], v11 offset:4608
  ds_read_b128 a[68:71], v109 offset:0
  v_mfma_f32_32x32x16_bf16 a[32:47], a[84:87], a[96:99], a[32:47]
  ds_read_b128 a[72:75], v109 offset:4096
  v_mfma_f32_32x32x16_bf16 a[48:63], a[84:87], a[100:103], a[48:63]
  ds_read_b128 a[76:79], v109 offset:16384
  ds_read_b128 a[80:83], v109 offset:20480
  s_waitcnt lgkmcnt(6)
  v_mfma_f32_32x32x16_bf16 a[0:15], a[104:107], a[108:111], a[0:15]
  ds_read_b64_tr_b16 a[84:85], v11 offset:6144
  v_mfma_f32_32x32x16_bf16 a[16:31], a[104:107], a[112:115], a[16:31]
  ds_read_b64_tr_b16 a[86:87], v11 offset:6656
  ds_read_b128 a[88:91], v111 offset:0
  v_mfma_f32_32x32x16_bf16 a[32:47], a[104:107], a[116:119], a[32:47]
  ds_read_b128 a[92:95], v111 offset:4096
  v_mfma_f32_32x32x16_bf16 a[48:63], a[104:107], a[120:123], a[48:63]
  ds_read_b128 a[96:99], v111 offset:16384
  ds_read_b128 a[100:103], v111 offset:20480
  s_waitcnt lgkmcnt(0)
  s_barrier
  v_mfma_f32_32x32x16_bf16 a[0:15], a[64:67], a[68:71], a[0:15]
  v_mfma_f32_32x32x16_bf16 a[16:31], a[64:67], a[72:75], a[16:31]
  v_mfma_f32_32x32x16_bf16 a[32:47], a[64:67], a[76:79], a[32:47]
  v_mfma_f32_32x32x16_bf16 a[48:63], a[64:67], a[80:83], a[48:63]
  v_mfma_f32_32x32x16_bf16 a[0:15], a[84:87], a[88:91], a[0:15]
  v_mfma_f32_32x32x16_bf16 a[16:31], a[84:87], a[92:95], a[16:31]
  v_mfma_f32_32x32x16_bf16 a[32:47], a[84:87], a[96:99], a[32:47]
  v_mfma_f32_32x32x16_bf16 a[48:63], a[84:87], a[100:103], a[48:63]
  s_waitcnt vmcnt(0)
  v_lshl_or_b32 v5, v113, 16, v112
  v_cndmask_b32 v96, 0, v5, s[54:55]
  v_cndmask_b32 v100, v5, 0, s[54:55]
  v_lshl_or_b32 v5, v115, 16, v114
  v_cndmask_b32 v97, 0, v5, s[54:55]
  v_cndmask_b32 v101, v5, 0, s[54:55]
  v_lshl_or_b32 v5, v117, 16, v116
  v_cndmask_b32 v98, 0, v5, s[54:55]
  v_cndmask_b32 v102, v5, 0, s[54:55]
  v_lshl_or_b32 v5, v119, 16, v118
  v_cndmask_b32 v99, 0, v5, s[54:55]
  v_cndmask_b32 v103, v5, 0, s[54:55]
  s_lshl_b32 s63, s86, 7
  s_lshl_b32 s4, s62, 1
  s_add_u32 s63, s63, s4
  s_lshl_b32 s63, s63, 10
  s_add_u32 s63, s63, 4194304
  v_lshlrev_b32 v14, 4, v1
  v_accvgpr_read_b32 v40, a0
  v_accvgpr_read_b32 v41, a1
  v_accvgpr_read_b32 v42, a2
  v_accvgpr_read_b32 v43, a3
  v_accvgpr_read_b32 v44, a4
  v_accvgpr_read_b32 v45, a5
  v_accvgpr_read_b32 v46, a6
  v_accvgpr_read_b32 v47, a7
  v_accvgpr_read_b32 v48, a8
  v_accvgpr_read_b32 v49, a9
  v_accvgpr_read_b32 v50, a10
  v_accvgpr_read_b32 v51, a11
  v_accvgpr_read_b32 v52, a12
  v_accvgpr_read_b32 v53, a13
  v_accvgpr_read_b32 v54, a14
  v_accvgpr_read_b32 v55, a15
  v_cvt_pk_bf16_f32 v16, v40, v41
  v_cvt_pk_bf16_f32 v20, v48, v49
  v_cvt_pk_bf16_f32 v17, v42, v43
  v_cvt_pk_bf16_f32 v21, v50, v51
  v_cvt_pk_bf16_f32 v18, v44, v45
  v_cvt_pk_bf16_f32 v22, v52, v53
  v_cvt_pk_bf16_f32 v19, v46, v47
  v_cvt_pk_bf16_f32 v23, v54, v55
  s_swappc_b64 s[56:57], s[58:59]
  v_accvgpr_write_b32 a0, v24
  v_accvgpr_write_b32 a1, v25
  v_accvgpr_write_b32 a2, v26
  v_accvgpr_write_b32 a3, v27
  v_accvgpr_write_b32 a4, v28
  v_accvgpr_write_b32 a5, v29
  v_accvgpr_write_b32 a6, v30
  v_accvgpr_write_b32 a7, v31
  v_accvgpr_write_b32 a8, v32
  v_accvgpr_write_b32 a9, v33
  v_accvgpr_write_b32 a10, v34
  v_accvgpr_write_b32 a11, v35
  v_accvgpr_write_b32 a12, v36
  v_accvgpr_write_b32 a13, v37
  v_accvgpr_write_b32 a14, v38
  v_accvgpr_write_b32 a15, v39
  v_mov_b32 v5, 162840
  s_mov_b32 s7, 1048576
L_ls_16:
  ds_read_b32 v6, v5
  s_waitcnt lgkmcnt(0)
  v_readfirstlane_b32 s4, v6
  s_nop 3
  s_cmp_ge_u32 s4, 1
  s_cbranch_scc1 L_lo_17
  s_sub_u32 s7, s7, 1
  s_cmp_eq_u32 s7, 0
  s_cbranch_scc1 L_lo_17
  s_sleep 1
  s_branch L_ls_16
L_lo_17:
  s_mul_i32 s4, s62, 4352
  s_add_u32 s4, s4, 6291456
  v_lshlrev_b32 v5, 4, v1
  v_lshlrev_b32 v6, 4, v3
  buffer_load_dwordx4 a[64:67], v5, s[28:31], s4 offen offset:0 sc1
  buffer_load_dwordx4 a[68:71], v5, s[28:31], s4 offen offset:1024 sc1
  buffer_load_dwordx4 a[72:75], v5, s[28:31], s4 offen offset:2048 sc1
  buffer_load_dwordx4 a[76:79], v5, s[28:31], s4 offen offset:3072 sc1
  s_add_u32 s4, s4, 4096
  buffer_load_dwordx4 a[80:83], v6, s[28:31], s4 offen offset:0 sc1
  buffer_load_dwordx4 a[96:99], v6, s[28:31], s4 offen offset:128 sc1
  buffer_load_dwordx4 a[84:87], v6, s[28:31], s4 offen offset:32 sc1
  buffer_load_dwordx4 a[100:103], v6, s[28:31], s4 offen offset:160 sc1
  buffer_load_dwordx4 a[88:91], v6, s[28:31], s4 offen offset:64 sc1
  buffer_load_dwordx4 a[104:107], v6, s[28:31], s4 offen offset:192 sc1
  buffer_load_dwordx4 a[92:95], v6, s[28:31], s4 offen offset:96 sc1
  buffer_load_dwordx4 a[108:111], v6, s[28:31], s4 offen offset:224 sc1
  v_accvgpr_read_b32 v40, a16
  v_accvgpr_read_b32 v41, a17
  v_accvgpr_read_b32 v42, a18
  v_accvgpr_read_b32 v43, a19
  v_accvgpr_read_b32 v44, a20
  v_accvgpr_read_b32 v45, a21
  v_accvgpr_read_b32 v46, a22
  v_accvgpr_read_b32 v47, a23
  v_accvgpr_read_b32 v48, a24
  v_accvgpr_read_b32 v49, a25
  v_accvgpr_read_b32 v50, a26
  v_accvgpr_read_b32 v51, a27
  v_accvgpr_read_b32 v52, a28
  v_accvgpr_read_b32 v53, a29
  v_accvgpr_read_b32 v54, a30
  v_accvgpr_read_b32 v55, a31
  v_cvt_pk_bf16_f32 v16, v40, v41
  v_cvt_pk_bf16_f32 v20, v48, v49
  v_cvt_pk_bf16_f32 v17, v42, v43
  v_cvt_pk_bf16_f32 v21, v50, v51
  v_cvt_pk_bf16_f32 v18, v44, v45
  v_cvt_pk_bf16_f32 v22, v52, v53
  v_cvt_pk_bf16_f32 v19, v46, v47
  v_cvt_pk_bf16_f32 v23, v54, v55
  s_swappc_b64 s[56:57], s[58:59]
  s_waitcnt vmcnt(0)
  v_accvgpr_read_b32 v40, a64
  v_accvgpr_read_b32 v41, a65
  v_accvgpr_read_b32 v42, a66
  v_accvgpr_read_b32 v43, a67
  v_accvgpr_read_b32 v44, a68
  v_accvgpr_read_b32 v45, a69
  v_accvgpr_read_b32 v46, a70
  v_accvgpr_read_b32 v47, a71
  v_accvgpr_read_b32 v48, a72
  v_accvgpr_read_b32 v49, a73
  v_accvgpr_read_b32 v50, a74
  v_accvgpr_read_b32 v51, a75
  v_accvgpr_read_b32 v52, a76
  v_accvgpr_read_b32 v53, a77
  v_accvgpr_read_b32 v54, a78
  v_accvgpr_read_b32 v55, a79
  v_accvgpr_read_b32 v56, a80
  v_accvgpr_read_b32 v57, a81
  v_accvgpr_read_b32 v58, a82
  v_accvgpr_read_b32 v59, a83
  v_accvgpr_read_b32 v60, a84
  v_accvgpr_read_b32 v61, a85
  v_accvgpr_read_b32 v62, a86
  v_accvgpr_read_b32 v63, a87
  v_accvgpr_read_b32 v64, a88
  v_accvgpr_read_b32 v65, a89
  v_accvgpr_read_b32 v66, a90
  v_accvgpr_read_b32 v67, a91
  v_accvgpr_read_b32 v68, a92
  v_accvgpr_read_b32 v69, a93
  v_accvgpr_read_b32 v70, a94
  v_accvgpr_read_b32 v71, a95
  v_accvgpr_read_b32 v72, a96
  v_accvgpr_read_b32 v73, a97
  v_accvgpr_read_b32 v74, a98
  v_accvgpr_read_b32 v75, a99
  v_accvgpr_read_b32 v76, a100
  v_accvgpr_read_b32 v77, a101
  v_accvgpr_read_b32 v78, a102
  v_accvgpr_read_b32 v79, a103
  v_accvgpr_read_b32 v80, a104
  v_accvgpr_read_b32 v81, a105
  v_accvgpr_read_b32 v82, a106
  v_accvgpr_read_b32 v83, a107
  v_accvgpr_read_b32 v84, a108
  v_accvgpr_read_b32 v85, a109
  v_accvgpr_read_b32 v86, a110
  v_accvgpr_read_b32 v87, a111
  v_cndmask_b32 v56, v56, v40, s[54:55]
  v_cndmask_b32 v72, v40, v72, s[54:55]
  v_cndmask_b32 v57, v57, v41, s[54:55]
  v_cndmask_b32 v73, v41, v73, s[54:55]
  v_cndmask_b32 v58, v58, v42, s[54:55]
  v_cndmask_b32 v74, v42, v74, s[54:55]
  v_cndmask_b32 v59, v59, v43, s[54:55]
  v_cndmask_b32 v75, v43, v75, s[54:55]
  v_cndmask_b32 v60, v60, v44, s[54:55]
  v_cndmask_b32 v76, v44, v76, s[54:55]
  v_cndmask_b32 v61, v61, v45, s[54:55]
  v_cndmask_b32 v77, v45, v77, s[54:55]
  v_cndmask_b32 v62, v62, v46, s[54:55]
  v_cndmask_b32 v78, v46, v78, s[54:55]
  v_cndmask_b32 v63, v63, v47, s[54:55]
  v_cndmask_b32 v79, v47, v79, s[54:55]
  v_cndmask_b32 v64, v64, v48, s[54:55]
  v_cndmask_b32 v80, v48, v80, s[54:55]
  v_cndmask_b32 v65, v65, v49, s[54:55]
  v_cndmask_b32 v81, v49, v81, s[54:55]
  v_cndmask_b32 v66, v66, v50, s[54:55]
  v_cndmask_b32 v82, v50, v82, s[54:55]
  v_cndmask_b32 v67, v67, v51, s[54:55]
  v_cndmask_b32 v83, v51, v83, s[54:55]
  v_cndmask_b32 v68, v68, v52, s[54:55]
  v_cndmask_b32 v84, v52, v84, s[54:55]
  v_cndmask_b32 v69, v69, v53, s[54:55]
  v_cndmask_b32 v85, v53, v85, s[54:55]
  v_cndmask_b32 v70, v70, v54, s[54:55]
  v_cndmask_b32 v86, v54, v86, s[54:55]
  v_cndmask_b32 v71, v71, v55, s[54:55]
  v_cndmask_b32 v87, v55, v87, s[54:55]
  v_cvt_pk_bf16_f32 v112, v56, v57
  v_cvt_pk_bf16_f32 v113, v58, v59
  v_cvt_pk_bf16_f32 v114, v60, v61
  v_cvt_pk_bf16_f32 v115, v62, v63
  v_cvt_pk_bf16_f32 v116, v64, v65
  v_cvt_pk_bf16_f32 v117, v66, v67
  v_cvt_pk_bf16_f32 v118, v68, v69
  v_cvt_pk_bf16_f32 v119, v70, v71
  v_cvt_pk_bf16_f32 v120, v72, v73
  v_cvt_pk_bf16_f32 v121, v74, v75
  v_cvt_pk_bf16_f32 v122, v76, v77
  v_cvt_pk_bf16_f32 v123, v78, v79
  v_cvt_pk_bf16_f32 v124, v80, v81
  v_cvt_pk_bf16_f32 v125, v82, v83
  v_cvt_pk_bf16_f32 v126, v84, v85
  v_cvt_pk_bf16_f32 v127, v86, v87
  v_mfma_f32_32x32x16_bf16 v[56:71], v[112:115], v[24:27], 0
  v_mfma_f32_32x32x16_bf16 v[72:87], v[120:123], v[32:35], 0
  v_mfma_f32_32x32x16_bf16 v[56:71], v[116:119], v[28:31], v[56:71]
  v_mfma_f32_32x32x16_bf16 v[72:87], v[124:127], v[36:39], v[72:87]
  s_nop 10
  v_add_f32 v88, 0x358637bd, v64
  v_add_f32 v89, 0x358637bd, v72
  v_rcp_f32 v90, v88
  v_rcp_f32 v91, v89
  s_nop 0
  v_pk_mul_f32 v[56:57], v[56:57], v[90:91] op_sel_hi:[1,0]
  v_pk_mul_f32 v[80:81], v[80:81], v[90:91] op_sel:[0,1] op_sel_hi:[1,1]
  v_pk_mul_f32 v[58:59], v[58:59], v[90:91] op_sel_hi:[1,0]
  v_pk_mul_f32 v[82:83], v[82:83], v[90:91] op_sel:[0,1] op_sel_hi:[1,1]
  v_pk_mul_f32 v[60:61], v[60:61], v[90:91] op_sel_hi:[1,0]
  v_pk_mul_f32 v[84:85], v[84:85], v[90:91] op_sel:[0,1] op_sel_hi:[1,1]
  v_pk_mul_f32 v[62:63], v[62:63], v[90:91] op_sel_hi:[1,0]
  v_pk_mul_f32 v[86:87], v[86:87], v[90:91] op_sel:[0,1] op_sel_hi:[1,1]
  v_cvt_pk_bf16_f32 v40, v56, v57
  v_cvt_pk_bf16_f32 v44, v80, v81
  v_cvt_pk_bf16_f32 v41, v58, v59
  v_cvt_pk_bf16_f32 v45, v82, v83
  v_cvt_pk_bf16_f32 v42, v60, v61
  v_cvt_pk_bf16_f32 v46, v84, v85
  v_cvt_pk_bf16_f32 v43, v62, v63
  v_cvt_pk_bf16_f32 v47, v86, v87
  s_add_u32 s5, s63, 32768
  buffer_store_dwordx4 v[40:43], v14, s[28:31], s5 offen sc1
  buffer_store_dwordx4 v[44:47], v14, s[28:31], s5 offen offset:1024 sc1
  v_mfma_f32_32x32x16_bf16 v[56:71], v[112:115], a[0:3], 0
  v_mfma_f32_32x32x16_bf16 v[72:87], v[120:123], a[8:11], 0
  v_mfma_f32_32x32x16_bf16 v[56:71], v[116:119], a[4:7], v[56:71]
  v_mfma_f32_32x32x16_bf16 v[72:87], v[124:127], a[12:15], v[72:87]
  s_nop 10
  v_add_f32 v88, 0x358637bd, v64
  v_add_f32 v89, 0x358637bd, v72
  v_rcp_f32 v90, v88
  v_rcp_f32 v91, v89
  s_nop 0
  v_pk_mul_f32 v[56:57], v[56:57], v[90:91] op_sel_hi:[1,0]
  v_pk_mul_f32 v[80:81], v[80:81], v[90:91] op_sel:[0,1] op_sel_hi:[1,1]
  v_pk_mul_f32 v[58:59], v[58:59], v[90:91] op_sel_hi:[1,0]
  v_pk_mul_f32 v[82:83], v[82:83], v[90:91] op_sel:[0,1] op_sel_hi:[1,1]
  v_pk_mul_f32 v[60:61], v[60:61], v[90:91] op_sel_hi:[1,0]
  v_pk_mul_f32 v[84:85], v[84:85], v[90:91] op_sel:[0,1] op_sel_hi:[1,1]
  v_pk_mul_f32 v[62:63], v[62:63], v[90:91] op_sel_hi:[1,0]
  v_pk_mul_f32 v[86:87], v[86:87], v[90:91] op_sel:[0,1] op_sel_hi:[1,1]
  v_cvt_pk_bf16_f32 v40, v56, v57
  v_cvt_pk_bf16_f32 v44, v80, v81
  v_cvt_pk_bf16_f32 v41, v58, v59
  v_cvt_pk_bf16_f32 v45, v82, v83
  v_cvt_pk_bf16_f32 v42, v60, v61
  v_cvt_pk_bf16_f32 v46, v84, v85
  v_cvt_pk_bf16_f32 v43, v62, v63
  v_cvt_pk_bf16_f32 v47, v86, v87
  s_add_u32 s5, s63, 0
  buffer_store_dwordx4 v[40:43], v14, s[28:31], s5 offen sc1
  buffer_store_dwordx4 v[44:47], v14, s[28:31], s5 offen offset:1024 sc1
  s_nop 0
  v_accvgpr_read_b32 v40, a32
  v_accvgpr_read_b32 v41, a33
  v_accvgpr_read_b32 v42, a34
  v_accvgpr_read_b32 v43, a35
  v_accvgpr_read_b32 v44, a36
  v_accvgpr_read_b32 v45, a37
  v_accvgpr_read_b32 v46, a38
  v_accvgpr_read_b32 v47, a39
  v_accvgpr_read_b32 v48, a40
  v_accvgpr_read_b32 v49, a41
  v_accvgpr_read_b32 v50, a42
  v_accvgpr_read_b32 v51, a43
  v_accvgpr_read_b32 v52, a44
  v_accvgpr_read_b32 v53, a45
  v_accvgpr_read_b32 v54, a46
  v_accvgpr_read_b32 v55, a47
  v_cvt_pk_bf16_f32 v16, v40, v41
  v_cvt_pk_bf16_f32 v20, v48, v49
  v_cvt_pk_bf16_f32 v17, v42, v43
  v_cvt_pk_bf16_f32 v21, v50, v51
  v_cvt_pk_bf16_f32 v18, v44, v45
  v_cvt_pk_bf16_f32 v22, v52, v53
  v_cvt_pk_bf16_f32 v19, v46, v47
  v_cvt_pk_bf16_f32 v23, v54, v55
  s_swappc_b64 s[56:57], s[58:59]
  v_mfma_f32_32x32x16_bf16 v[56:71], v[112:115], v[24:27], 0
  v_mfma_f32_32x32x16_bf16 v[72:87], v[120:123], v[32:35], 0
  v_mfma_f32_32x32x16_bf16 v[56:71], v[116:119], v[28:31], v[56:71]
  v_mfma_f32_32x32x16_bf16 v[72:87], v[124:127], v[36:39], v[72:87]
  s_nop 10
  v_add_f32 v88, 0x358637bd, v64
  v_add_f32 v89, 0x358637bd, v72
  v_rcp_f32 v90, v88
  v_rcp_f32 v91, v89
  s_nop 0
  v_pk_mul_f32 v[56:57], v[56:57], v[90:91] op_sel_hi:[1,0]
  v_pk_mul_f32 v[80:81], v[80:81], v[90:91] op_sel:[0,1] op_sel_hi:[1,1]
  v_pk_mul_f32 v[58:59], v[58:59], v[90:91] op_sel_hi:[1,0]
  v_pk_mul_f32 v[82:83], v[82:83], v[90:91] op_sel:[0,1] op_sel_hi:[1,1]
  v_pk_mul_f32 v[60:61], v[60:61], v[90:91] op_sel_hi:[1,0]
  v_pk_mul_f32 v[84:85], v[84:85], v[90:91] op_sel:[0,1] op_sel_hi:[1,1]
  v_pk_mul_f32 v[62:63], v[62:63], v[90:91] op_sel_hi:[1,0]
  v_pk_mul_f32 v[86:87], v[86:87], v[90:91] op_sel:[0,1] op_sel_hi:[1,1]
  v_cvt_pk_bf16_f32 v40, v56, v57
  v_cvt_pk_bf16_f32 v44, v80, v81
  v_cvt_pk_bf16_f32 v41, v58, v59
  v_cvt_pk_bf16_f32 v45, v82, v83
  v_cvt_pk_bf16_f32 v42, v60, v61
  v_cvt_pk_bf16_f32 v46, v84, v85
  v_cvt_pk_bf16_f32 v43, v62, v63
  v_cvt_pk_bf16_f32 v47, v86, v87
  s_add_u32 s5, s63, 65536
  buffer_store_dwordx4 v[40:43], v14, s[28:31], s5 offen sc1
  buffer_store_dwordx4 v[44:47], v14, s[28:31], s5 offen offset:1024 sc1
  s_nop 0
  v_accvgpr_read_b32 v40, a48
  v_accvgpr_read_b32 v41, a49
  v_accvgpr_read_b32 v42, a50
  v_accvgpr_read_b32 v43, a51
  v_accvgpr_read_b32 v44, a52
  v_accvgpr_read_b32 v45, a53
  v_accvgpr_read_b32 v46, a54
  v_accvgpr_read_b32 v47, a55
  v_accvgpr_read_b32 v48, a56
  v_accvgpr_read_b32 v49, a57
  v_accvgpr_read_b32 v50, a58
  v_accvgpr_read_b32 v51, a59
  v_accvgpr_read_b32 v52, a60
  v_accvgpr_read_b32 v53, a61
  v_accvgpr_read_b32 v54, a62
  v_accvgpr_read_b32 v55, a63
  v_cvt_pk_bf16_f32 v16, v40, v41
  v_cvt_pk_bf16_f32 v20, v48, v49
  v_cvt_pk_bf16_f32 v17, v42, v43
  v_cvt_pk_bf16_f32 v21, v50, v51
  v_cvt_pk_bf16_f32 v18, v44, v45
  v_cvt_pk_bf16_f32 v22, v52, v53
  v_cvt_pk_bf16_f32 v19, v46, v47
  v_cvt_pk_bf16_f32 v23, v54, v55
  s_swappc_b64 s[56:57], s[58:59]
  v_mfma_f32_32x32x16_bf16 v[56:71], v[112:115], v[24:27], 0
  v_mfma_f32_32x32x16_bf16 v[72:87], v[120:123], v[32:35], 0
  v_mfma_f32_32x32x16_bf16 v[56:71], v[116:119], v[28:31], v[56:71]
  v_mfma_f32_32x32x16_bf16 v[72:87], v[124:127], v[36:39], v[72:87]
  s_nop 10
  v_add_f32 v88, 0x358637bd, v64
  v_add_f32 v89, 0x358637bd, v72
  v_rcp_f32 v90, v88
  v_rcp_f32 v91, v89
  s_nop 0
  v_pk_mul_f32 v[56:57], v[56:57], v[90:91] op_sel_hi:[1,0]
  v_pk_mul_f32 v[80:81], v[80:81], v[90:91] op_sel:[0,1] op_sel_hi:[1,1]
  v_pk_mul_f32 v[58:59], v[58:59], v[90:91] op_sel_hi:[1,0]
  v_pk_mul_f32 v[82:83], v[82:83], v[90:91] op_sel:[0,1] op_sel_hi:[1,1]
  v_pk_mul_f32 v[60:61], v[60:61], v[90:91] op_sel_hi:[1,0]
  v_pk_mul_f32 v[84:85], v[84:85], v[90:91] op_sel:[0,1] op_sel_hi:[1,1]
  v_pk_mul_f32 v[62:63], v[62:63], v[90:91] op_sel_hi:[1,0]
  v_pk_mul_f32 v[86:87], v[86:87], v[90:91] op_sel:[0,1] op_sel_hi:[1,1]
  v_cvt_pk_bf16_f32 v40, v56, v57
  v_cvt_pk_bf16_f32 v44, v80, v81
  v_cvt_pk_bf16_f32 v41, v58, v59
  v_cvt_pk_bf16_f32 v45, v82, v83
  v_cvt_pk_bf16_f32 v42, v60, v61
  v_cvt_pk_bf16_f32 v46, v84, v85
  v_cvt_pk_bf16_f32 v43, v62, v63
  v_cvt_pk_bf16_f32 v47, v86, v87
  s_add_u32 s5, s63, 98304
  buffer_store_dwordx4 v[40:43], v14, s[28:31], s5 offen sc1
  buffer_store_dwordx4 v[44:47], v14, s[28:31], s5 offen offset:1024 sc1
  s_waitcnt vmcnt(0)
  v_mov_b32 v5, 162832
  v_mov_b32 v6, 1
  s_mov_b64 exec, 1
  ds_add_rtn_u32 v7, v5, v6
  s_waitcnt lgkmcnt(0)
  v_readfirstlane_b32 s4, v7
  s_nop 3
  s_cmp_lg_u32 s4, 3
  s_cbranch_scc1 L_el_18
  v_mov_b32 v5, s94
  buffer_store_dword v6, v5, s[28:31], 0 offen sc1
L_el_18:
  s_mov_b64 exec, -1
  s_branch L_c_merge
L_c_i:
  s_waitcnt vmcnt(0)
  v_mov_b32 v5, 162828
  v_mov_b32 v6, 1
  s_mov_b64 exec, 1
  ds_add_rtn_u32 v7, v5, v6
  s_waitcnt lgkmcnt(0)
  v_readfirstlane_b32 s4, v7
  s_nop 3
  s_cmp_lg_u32 s4, 3
  s_cbranch_scc1 L_el_19
  v_mov_b32 v5, s93
  buffer_store_dword v6, v5, s[28:31], 0 offen sc1
L_el_19:
  s_mov_b64 exec, -1
  s_branch L_c_merge
L_c_b1:
  s_and_b32 s4, s79, 1
  s_lshl_b32 s4, s4, 6
  s_lshl_b32 s5, s87, 7
  s_add_u32 s4, s4, s5
  v_lshlrev_b32 v5, 3, v3
  buffer_load_dwordx2 v[32:33], v5, s[40:43], s4 offen offset:0
  buffer_load_dwordx2 v[34:35], v5, s[40:43], s4 offen offset:16
  buffer_load_dwordx2 v[36:37], v5, s[40:43], s4 offen offset:32
  buffer_load_dwordx2 v[38:39], v5, s[40:43], s4 offen offset:48
  s_and_b32 s6, s79, 1
  s_lshl_b32 s6, s6, 6
  v_bfe_u32 v5, v1, 2, 2
  v_lshl_add_u32 v6, v3, 3, v5
  v_lshlrev_b32 v6, 7, v6
  v_lshrrev_b32 v5, 1, v5
  v_lshlrev_b32 v5, 6, v5
  v_xor_b32 v5, s6, v5
  v_add_u32 v6, v6, v5
  v_bfe_u32 v5, v1, 4, 1
  v_lshl_add_u32 v6, v5, 5, v6
  v_and_b32 v5, 3, v1
  v_lshl_add_u32 v10, v5, 3, v6
  v_add_u32 v11, 65536, v10
  s_lshr_b32 s4, s79, 1
  s_lshl_b32 s4, s4, 9
  v_lshlrev_b32 v5, 4, v2
  v_lshl_add_u32 v5, v3, 10, v5
  v_add_u32 v12, s4, v5
  v_add_u32 v13, 65536, v12
  s_barrier
  s_waitcnt vmcnt(0)
  v_lshlrev_b32 v40, 16, v32
  v_and_b32 v41, 0xffff0000, v32
  v_lshlrev_b32 v42, 16, v33
  v_and_b32 v43, 0xffff0000, v33
  v_lshlrev_b32 v44, 16, v34
  v_and_b32 v45, 0xffff0000, v34
  v_lshlrev_b32 v46, 16, v35
  v_and_b32 v47, 0xffff0000, v35
  v_lshlrev_b32 v48, 16, v36
  v_and_b32 v49, 0xffff0000, v36
  v_lshlrev_b32 v50, 16, v37
  v_and_b32 v51, 0xffff0000, v37
  v_lshlrev_b32 v52, 16, v38
  v_and_b32 v53, 0xffff0000, v38
  v_lshlrev_b32 v54, 16, v39
  v_and_b32 v55, 0xffff0000, v39
  ds_read_b64_tr_b16 a[0:1], v11 offset:16384
  ds_read_b64_tr_b16 a[2:3], v11 offset:16896
  ds_read_b128 a[4:7], v13 offset:24576
  ds_read_b64_tr_b16 a[8:9], v11 offset:18432
  ds_read_b64_tr_b16 a[10:11], v11 offset:18944
  ds_read_b128 a[12:15], v13 offset:26624
  ds_read_b64_tr_b16 a[16:17], v11 offset:20480
  ds_read_b64_tr_b16 a[18:19], v11 offset:20992
  ds_read_b128 a[20:23], v13 offset:28672
  ds_read_b64_tr_b16 a[24:25], v11 offset:22528
  ds_read_b64_tr_b16 a[26:27], v11 offset:23040
  ds_read_b128 a[28:31], v13 offset:30720
  s_barrier
  ds_read_b64_tr_b16 a[32:33], v11 offset:32768
  ds_read_b64_tr_b16 a[34:35], v11 offset:33280
  ds_read_b128 a[36:39], v13 offset:40960
  ds_read_b64_tr_b16 a[40:41], v11 offset:34816
  ds_read_b64_tr_b16 a[42:43], v11 offset:35328
  ds_read_b128 a[44:47], v13 offset:43008
  ds_read_b64_tr_b16 a[48:49], v11 offset:36864
  ds_read_b64_tr_b16 a[50:51], v11 offset:37376
  ds_read_b128 a[52:55], v13 offset:45056
  ds_read_b64_tr_b16 a[56:57], v11 offset:38912
  ds_read_b64_tr_b16 a[58:59], v11 offset:39424
  ds_read_b128 a[60:63], v13 offset:47104
  s_waitcnt lgkmcnt(12)
  s_barrier
  v_mfma_f32_32x32x16_bf16 v[40:55], a[0:3], a[4:7], v[40:55]
  ds_read_b64_tr_b16 a[64:65], v11 offset:49152
  ds_read_b64_tr_b16 a[66:67], v11 offset:49664
  ds_read_b128 a[68:71], v13 offset:57344
  ds_read_b64_tr_b16 a[72:73], v11 offset:51200
  ds_read_b64_tr_b16 a[74:75], v11 offset:51712
  ds_read_b128 a[76:79], v13 offset:59392
  v_mfma_f32_32x32x16_bf16 v[40:55], a[8:11], a[12:15], v[40:55]
  ds_read_b64_tr_b16 a[80:81], v11 offset:53248
  ds_read_b64_tr_b16 a[82:83], v11 offset:53760
  ds_read_b128 a[84:87], v13 offset:61440
  ds_read_b64_tr_b16 a[88:89], v11 offset:55296
  ds_read_b64_tr_b16 a[90:91], v11 offset:55808
  ds_read_b128 a[92:95], v13 offset:63488
  v_mfma_f32_32x32x16_bf16 v[40:55], a[16:19], a[20:23], v[40:55]
  v_mfma_f32_32x32x16_bf16 v[40:55], a[24:27], a[28:31], v[40:55]
  s_waitcnt lgkmcnt(12)
  s_barrier
  v_mov_b32 v5, 162828
  v_mov_b32 v6, 1
  s_mov_b64 exec, 1
  ds_add_rtn_u32 v7, v5, v6
  s_waitcnt lgkmcnt(0)
  v_readfirstlane_b32 s4, v7
  s_nop 3
  s_cmp_lg_u32 s4, 3
  s_cbranch_scc1 L_el_13
  v_mov_b32 v5, s93
  buffer_store_dword v6, v5, s[28:31], 0 offen sc1
L_el_13:
  s_mov_b64 exec, -1
  v_mfma_f32_32x32x16_bf16 v[40:55], a[32:35], a[36:39], v[40:55]
  ds_read_b64_tr_b16 a[0:1], v10 offset:0
  ds_read_b64_tr_b16 a[2:3], v10 offset:512
  ds_read_b128 a[4:7], v12 offset:8192
  ds_read_b64_tr_b16 a[8:9], v10 offset:2048
  ds_read_b64_tr_b16 a[10:11], v10 offset:2560
  ds_read_b128 a[12:15], v12 offset:10240
  v_mfma_f32_32x32x16_bf16 v[40:55], a[40:43], a[44:47], v[40:55]
  ds_read_b64_tr_b16 a[16:17], v10 offset:4096
  ds_read_b64_tr_b16 a[18:19], v10 offset:4608
  ds_read_b128 a[20:23], v12 offset:12288
  ds_read_b64_tr_b16 a[24:25], v10 offset:6144
  ds_read_b64_tr_b16 a[26:27], v10 offset:6656
  ds_read_b128 a[28:31], v12 offset:14336
  v_mfma_f32_32x32x16_bf16 v[40:55], a[48:51], a[52:55], v[40:55]
  v_mfma_f32_32x32x16_bf16 v[40:55], a[56:59], a[60:63], v[40:55]
  s_waitcnt lgkmcnt(12)
  s_barrier
  v_mfma_f32_32x32x16_bf16 v[40:55], a[64:67], a[68:71], v[40:55]
  ds_read_b64_tr_b16 a[32:33], v10 offset:16384
  ds_read_b64_tr_b16 a[34:35], v10 offset:16896
  ds_read_b128 a[36:39], v12 offset:24576
  ds_read_b64_tr_b16 a[40:41], v10 offset:18432
  ds_read_b64_tr_b16 a[42:43], v10 offset:18944
  ds_read_b128 a[44:47], v12 offset:26624
  v_mfma_f32_32x32x16_bf16 v[40:55], a[72:75], a[76:79], v[40:55]
  ds_read_b64_tr_b16 a[48:49], v10 offset:20480
  ds_read_b64_tr_b16 a[50:51], v10 offset:20992
  ds_read_b128 a[52:55], v12 offset:28672
  ds_read_b64_tr_b16 a[56:57], v10 offset:22528
  ds_read_b64_tr_b16 a[58:59], v10 offset:23040
  ds_read_b128 a[60:63], v12 offset:30720
  v_mfma_f32_32x32x16_bf16 v[40:55], a[80:83], a[84:87], v[40:55]
  v_mfma_f32_32x32x16_bf16 v[40:55], a[88:91], a[92:95], v[40:55]
  s_waitcnt lgkmcnt(12)
  s_barrier
  v_mfma_f32_32x32x16_bf16 v[40:55], a[0:3], a[4:7], v[40:55]
  ds_read_b64_tr_b16 a[64:65], v10 offset:32768
  ds_read_b64_tr_b16 a[66:67], v10 offset:33280
  ds_read_b128 a[68:71], v12 offset:40960
  ds_read_b64_tr_b16 a[72:73], v10 offset:34816
  ds_read_b64_tr_b16 a[74:75], v10 offset:35328
  ds_read_b128 a[76:79], v12 offset:43008
  v_mfma_f32_32x32x16_bf16 v[40:55], a[8:11], a[12:15], v[40:55]
  ds_read_b64_tr_b16 a[80:81], v10 offset:36864
  ds_read_b64_tr_b16 a[82:83], v10 offset:37376
  ds_read_b128 a[84:87], v12 offset:45056
  ds_read_b64_tr_b16 a[88:89], v10 offset:38912
  ds_read_b64_tr_b16 a[90:91], v10 offset:39424
  ds_read_b128 a[92:95], v12 offset:47104
  v_mfma_f32_32x32x16_bf16 v[40:55], a[16:19], a[20:23], v[40:55]
  v_mfma_f32_32x32x16_bf16 v[40:55], a[24:27], a[28:31], v[40:55]
  s_waitcnt lgkmcnt(12)
  s_barrier
  v_mfma_f32_32x32x16_bf16 v[40:55], a[32:35], a[36:39], v[40:55]
  ds_read_b64_tr_b16 a[0:1], v10 offset:49152
  ds_read_b64_tr_b16 a[2:3], v10 offset:49664
  ds_read_b128 a[4:7], v12 offset:57344
  ds_read_b64_tr_b16 a[8:9], v10 offset:51200
  ds_read_b64_tr_b16 a[10:11], v10 offset:51712
  ds_read_b128 a[12:15], v12 offset:59392
  v_mfma_f32_32x32x16_bf16 v[40:55], a[40:43], a[44:47], v[40:55]
  ds_read_b64_tr_b16 a[16:17], v10 offset:53248
  ds_read_b64_tr_b16 a[18:19], v10 offset:53760
  ds_read_b128 a[20:23], v12 offset:61440
  ds_read_b64_tr_b16 a[24:25], v10 offset:55296
  ds_read_b64_tr_b16 a[26:27], v10 offset:55808
  ds_read_b128 a[28:31], v12 offset:63488
  v_mfma_f32_32x32x16_bf16 v[40:55], a[48:51], a[52:55], v[40:55]
  v_mfma_f32_32x32x16_bf16 v[40:55], a[56:59], a[60:63], v[40:55]
  s_waitcnt lgkmcnt(12)
  s_barrier
  v_mfma_f32_32x32x16_bf16 v[40:55], a[64:67], a[68:71], v[40:55]
  ds_read_b64_tr_b16 a[32:33], v11 offset:0
  ds_read_b64_tr_b16 a[34:35], v11 offset:512
  ds_read_b128 a[36:39], v13 offset:8192
  ds_read_b64_tr_b16 a[40:41], v11 offset:2048
  ds_read_b64_tr_b16 a[42:43], v11 offset:2560
  ds_read_b128 a[44:47], v13 offset:10240
  v_mfma_f32_32x32x16_bf16 v[40:55], a[72:75], a[76:79], v[40:55]
  ds_read_b64_tr_b16 a[48:49], v11 offset:4096
  ds_read_b64_tr_b16 a[50:51], v11 offset:4608
  ds_read_b128 a[52:55], v13 offset:12288
  ds_read_b64_tr_b16 a[56:57], v11 offset:6144
  ds_read_b64_tr_b16 a[58:59], v11 offset:6656
  ds_read_b128 a[60:63], v13 offset:14336
  v_mfma_f32_32x32x16_bf16 v[40:55], a[80:83], a[84:87], v[40:55]
  v_mfma_f32_32x32x16_bf16 v[40:55], a[88:91], a[92:95], v[40:55]
  s_waitcnt lgkmcnt(12)
  s_barrier
  v_mfma_f32_32x32x16_bf16 v[40:55], a[0:3], a[4:7], v[40:55]
  ds_read_b64_tr_b16 a[64:65], v11 offset:16384
  ds_read_b64_tr_b16 a[66:67], v11 offset:16896
  ds_read_b128 a[68:71], v13 offset:24576
  ds_read_b64_tr_b16 a[72:73], v11 offset:18432
  ds_read_b64_tr_b16 a[74:75], v11 offset:18944
  ds_read_b128 a[76:79], v13 offset:26624
  v_mfma_f32_32x32x16_bf16 v[40:55], a[8:11], a[12:15], v[40:55]
  ds_read_b64_tr_b16 a[80:81], v11 offset:20480
  ds_read_b64_tr_b16 a[82:83], v11 offset:20992
  ds_read_b128 a[84:87], v13 offset:28672
  ds_read_b64_tr_b16 a[88:89], v11 offset:22528
  ds_read_b64_tr_b16 a[90:91], v11 offset:23040
  ds_read_b128 a[92:95], v13 offset:30720
  v_mfma_f32_32x32x16_bf16 v[40:55], a[16:19], a[20:23], v[40:55]
  v_mfma_f32_32x32x16_bf16 v[40:55], a[24:27], a[28:31], v[40:55]
  s_waitcnt lgkmcnt(12)
  s_barrier
  v_mfma_f32_32x32x16_bf16 v[40:55], a[32:35], a[36:39], v[40:55]
  ds_read_b64_tr_b16 a[0:1], v11 offset:32768
  ds_read_b64_tr_b16 a[2:3], v11 offset:33280
  ds_read_b128 a[4:7], v13 offset:40960
  ds_read_b64_tr_b16 a[8:9], v11 offset:34816
  ds_read_b64_tr_b16 a[10:11], v11 offset:35328
  ds_read_b128 a[12:15], v13 offset:43008
  v_mfma_f32_32x32x16_bf16 v[40:55], a[40:43], a[44:47], v[40:55]
  ds_read_b64_tr_b16 a[16:17], v11 offset:36864
  ds_read_b64_tr_b16 a[18:19], v11 offset:37376
  ds_read_b128 a[20:23], v13 offset:45056
  ds_read_b64_tr_b16 a[24:25], v11 offset:38912
  ds_read_b64_tr_b16 a[26:27], v11 offset:39424
  ds_read_b128 a[28:31], v13 offset:47104
  v_mfma_f32_32x32x16_bf16 v[40:55], a[48:51], a[52:55], v[40:55]
  v_mfma_f32_32x32x16_bf16 v[40:55], a[56:59], a[60:63], v[40:55]
  s_waitcnt lgkmcnt(12)
  s_barrier
  v_mfma_f32_32x32x16_bf16 v[40:55], a[64:67], a[68:71], v[40:55]
  ds_read_b64_tr_b16 a[32:33], v11 offset:49152
  ds_read_b64_tr_b16 a[34:35], v11 offset:49664
  ds_read_b128 a[36:39], v13 offset:57344
  ds_read_b64_tr_b16 a[40:41], v11 offset:51200
  ds_read_b64_tr_b16 a[42:43], v11 offset:51712
  ds_read_b128 a[44:47], v13 offset:59392
  v_mfma_f32_32x32x16_bf16 v[40:55], a[72:75], a[76:79], v[40:55]
  ds_read_b64_tr_b16 a[48:49], v11 offset:53248
  ds_read_b64_tr_b16 a[50:51], v11 offset:53760
  ds_read_b128 a[52:55], v13 offset:61440
  ds_read_b64_tr_b16 a[56:57], v11 offset:55296
  ds_read_b64_tr_b16 a[58:59], v11 offset:55808
  ds_read_b128 a[60:63], v13 offset:63488
  v_mfma_f32_32x32x16_bf16 v[40:55], a[80:83], a[84:87], v[40:55]
  v_mfma_f32_32x32x16_bf16 v[40:55], a[88:91], a[92:95], v[40:55]
  s_waitcnt lgkmcnt(12)
  s_barrier
  v_mfma_f32_32x32x16_bf16 v[40:55], a[0:3], a[4:7], v[40:55]
  ds_read_b64_tr_b16 a[64:65], v10 offset:0
  ds_read_b64_tr_b16 a[66:67], v10 offset:512
  ds_read_b128 a[68:71], v12 offset:8192
  ds_read_b64_tr_b16 a[72:73], v10 offset:2048
  ds_read_b64_tr_b16 a[74:75], v10 offset:2560
  ds_read_b128 a[76:79], v12 offset:10240
  v_mfma_f32_32x32x16_bf16 v[40:55], a[8:11], a[12:15], v[40:55]
  ds_read_b64_tr_b16 a[80:81], v10 offset:4096
  ds_read_b64_tr_b16 a[82:83], v10 offset:4608
  ds_read_b128 a[84:87], v12 offset:12288
  ds_read_b64_tr_b16 a[88:89], v10 offset:6144
  ds_read_b64_tr_b16 a[90:91], v10 offset:6656
  ds_read_b128 a[92:95], v12 offset:14336
  v_mfma_f32_32x32x16_bf16 v[40:55], a[16:19], a[20:23], v[40:55]
  v_mfma_f32_32x32x16_bf16 v[40:55], a[24:27], a[28:31], v[40:55]
  s_waitcnt lgkmcnt(12)
  s_barrier
  v_mfma_f32_32x32x16_bf16 v[40:55], a[32:35], a[36:39], v[40:55]
  ds_read_b64_tr_b16 a[0:1], v10 offset:16384
  ds_read_b64_tr_b16 a[2:3], v10 offset:16896
  ds_read_b128 a[4:7], v12 offset:24576
  ds_read_b64_tr_b16 a[8:9], v10 offset:18432
  ds_read_b64_tr_b16 a[10:11], v10 offset:18944
  ds_read_b128 a[12:15], v12 offset:26624
  v_mfma_f32_32x32x16_bf16 v[40:55], a[40:43], a[44:47], v[40:55]
  ds_read_b64_tr_b16 a[16:17], v10 offset:20480
  ds_read_b64_tr_b16 a[18:19], v10 offset:20992
  ds_read_b128 a[20:23], v12 offset:28672
  ds_read_b64_tr_b16 a[24:25], v10 offset:22528
  ds_read_b64_tr_b16 a[26:27], v10 offset:23040
  ds_read_b128 a[28:31], v12 offset:30720
  v_mfma_f32_32x32x16_bf16 v[40:55], a[48:51], a[52:55], v[40:55]
  v_mfma_f32_32x32x16_bf16 v[40:55], a[56:59], a[60:63], v[40:55]
  s_waitcnt lgkmcnt(12)
  s_barrier
  v_mfma_f32_32x32x16_bf16 v[40:55], a[64:67], a[68:71], v[40:55]
  ds_read_b64_tr_b16 a[32:33], v10 offset:32768
  ds_read_b64_tr_b16 a[34:35], v10 offset:33280
  ds_read_b128 a[36:39], v12 offset:40960
  ds_read_b64_tr_b16 a[40:41], v10 offset:34816
  ds_read_b64_tr_b16 a[42:43], v10 offset:35328
  ds_read_b128 a[44:47], v12 offset:43008
  v_mfma_f32_32x32x16_bf16 v[40:55], a[72:75], a[76:79], v[40:55]
  ds_read_b64_tr_b16 a[48:49], v10 offset:36864
  ds_read_b64_tr_b16 a[50:51], v10 offset:37376
  ds_read_b128 a[52:55], v12 offset:45056
  ds_read_b64_tr_b16 a[56:57], v10 offset:38912
  ds_read_b64_tr_b16 a[58:59], v10 offset:39424
  ds_read_b128 a[60:63], v12 offset:47104
  v_mfma_f32_32x32x16_bf16 v[40:55], a[80:83], a[84:87], v[40:55]
  v_mfma_f32_32x32x16_bf16 v[40:55], a[88:91], a[92:95], v[40:55]
  s_waitcnt lgkmcnt(12)
  s_barrier
  v_mfma_f32_32x32x16_bf16 v[40:55], a[0:3], a[4:7], v[40:55]
  ds_read_b64_tr_b16 a[64:65], v10 offset:49152
  ds_read_b64_tr_b16 a[66:67], v10 offset:49664
  ds_read_b128 a[68:71], v12 offset:57344
  ds_read_b64_tr_b16 a[72:73], v10 offset:51200
  ds_read_b64_tr_b16 a[74:75], v10 offset:51712
  ds_read_b128 a[76:79], v12 offset:59392
  v_mfma_f32_32x32x16_bf16 v[40:55], a[8:11], a[12:15], v[40:55]
  ds_read_b64_tr_b16 a[80:81], v10 offset:53248
  ds_read_b64_tr_b16 a[82:83], v10 offset:53760
  ds_read_b128 a[84:87], v12 offset:61440
  ds_read_b64_tr_b16 a[88:89], v10 offset:55296
  ds_read_b64_tr_b16 a[90:91], v10 offset:55808
  ds_read_b128 a[92:95], v12 offset:63488
  v_mfma_f32_32x32x16_bf16 v[40:55], a[16:19], a[20:23], v[40:55]
  v_mfma_f32_32x32x16_bf16 v[40:55], a[24:27], a[28:31], v[40:55]
  s_waitcnt lgkmcnt(12)
  s_barrier
  v_mfma_f32_32x32x16_bf16 v[40:55], a[32:35], a[36:39], v[40:55]
  ds_read_b64_tr_b16 a[0:1], v11 offset:0
  ds_read_b64_tr_b16 a[2:3], v11 offset:512
  ds_read_b128 a[4:7], v13 offset:8192
  ds_read_b64_tr_b16 a[8:9], v11 offset:2048
  ds_read_b64_tr_b16 a[10:11], v11 offset:2560
  ds_read_b128 a[12:15], v13 offset:10240
  v_mfma_f32_32x32x16_bf16 v[40:55], a[40:43], a[44:47], v[40:55]
  ds_read_b64_tr_b16 a[16:17], v11 offset:4096
  ds_read_b64_tr_b16 a[18:19], v11 offset:4608
  ds_read_b128 a[20:23], v13 offset:12288
  ds_read_b64_tr_b16 a[24:25], v11 offset:6144
  ds_read_b64_tr_b16 a[26:27], v11 offset:6656
  ds_read_b128 a[28:31], v13 offset:14336
  v_mfma_f32_32x32x16_bf16 v[40:55], a[48:51], a[52:55], v[40:55]
  v_mfma_f32_32x32x16_bf16 v[40:55], a[56:59], a[60:63], v[40:55]
  s_waitcnt lgkmcnt(12)
  s_barrier
  v_mfma_f32_32x32x16_bf16 v[40:55], a[64:67], a[68:71], v[40:55]
  ds_read_b64_tr_b16 a[32:33], v11 offset:16384
  ds_read_b64_tr_b16 a[34:35], v11 offset:16896
  ds_read_b128 a[36:39], v13 offset:24576
  ds_read_b64_tr_b16 a[40:41], v11 offset:18432
  ds_read_b64_tr_b16 a[42:43], v11 offset:18944
  ds_read_b128 a[44:47], v13 offset:26624
  v_mfma_f32_32x32x16_bf16 v[40:55], a[72:75], a[76:79], v[40:55]
  ds_read_b64_tr_b16 a[48:49], v11 offset:20480
  ds_read_b64_tr_b16 a[50:51], v11 offset:20992
  ds_read_b128 a[52:55], v13 offset:28672
  ds_read_b64_tr_b16 a[56:57], v11 offset:22528
  ds_read_b64_tr_b16 a[58:59], v11 offset:23040
  ds_read_b128 a[60:63], v13 offset:30720
  v_mfma_f32_32x32x16_bf16 v[40:55], a[80:83], a[84:87], v[40:55]
  v_mfma_f32_32x32x16_bf16 v[40:55], a[88:91], a[92:95], v[40:55]
  s_waitcnt lgkmcnt(12)
  s_barrier
  v_mfma_f32_32x32x16_bf16 v[40:55], a[0:3], a[4:7], v[40:55]
  ds_read_b64_tr_b16 a[64:65], v11 offset:32768
  ds_read_b64_tr_b16 a[66:67], v11 offset:33280
  ds_read_b128 a[68:71], v13 offset:40960
  ds_read_b64_tr_b16 a[72:73], v11 offset:34816
  ds_read_b64_tr_b16 a[74:75], v11 offset:35328
  ds_read_b128 a[76:79], v13 offset:43008
  v_mfma_f32_32x32x16_bf16 v[40:55], a[8:11], a[12:15], v[40:55]
  ds_read_b64_tr_b16 a[80:81], v11 offset:36864
  ds_read_b64_tr_b16 a[82:83], v11 offset:37376
  ds_read_b128 a[84:87], v13 offset:45056
  ds_read_b64_tr_b16 a[88:89], v11 offset:38912
  ds_read_b64_tr_b16 a[90:91], v11 offset:39424
  ds_read_b128 a[92:95], v13 offset:47104
  v_mfma_f32_32x32x16_bf16 v[40:55], a[16:19], a[20:23], v[40:55]
  v_mfma_f32_32x32x16_bf16 v[40:55], a[24:27], a[28:31], v[40:55]
  s_waitcnt lgkmcnt(12)
  s_barrier
  v_mfma_f32_32x32x16_bf16 v[40:55], a[32:35], a[36:39], v[40:55]
  ds_read_b64_tr_b16 a[0:1], v11 offset:49152
  ds_read_b64_tr_b16 a[2:3], v11 offset:49664
  ds_read_b128 a[4:7], v13 offset:57344
  ds_read_b64_tr_b16 a[8:9], v11 offset:51200
  ds_read_b64_tr_b16 a[10:11], v11 offset:51712
  ds_read_b128 a[12:15], v13 offset:59392
  v_mfma_f32_32x32x16_bf16 v[40:55], a[40:43], a[44:47], v[40:55]
  ds_read_b64_tr_b16 a[16:17], v11 offset:53248
  ds_read_b64_tr_b16 a[18:19], v11 offset:53760
  ds_read_b128 a[20:23], v13 offset:61440
  ds_read_b64_tr_b16 a[24:25], v11 offset:55296
  ds_read_b64_tr_b16 a[26:27], v11 offset:55808
  ds_read_b128 a[28:31], v13 offset:63488
  v_mfma_f32_32x32x16_bf16 v[40:55], a[48:51], a[52:55], v[40:55]
  v_mfma_f32_32x32x16_bf16 v[40:55], a[56:59], a[60:63], v[40:55]
  s_waitcnt lgkmcnt(12)
  s_barrier
  v_mfma_f32_32x32x16_bf16 v[40:55], a[64:67], a[68:71], v[40:55]
  ds_read_b64_tr_b16 a[32:33], v10 offset:0
  ds_read_b64_tr_b16 a[34:35], v10 offset:512
  ds_read_b128 a[36:39], v12 offset:8192
  ds_read_b64_tr_b16 a[40:41], v10 offset:2048
  ds_read_b64_tr_b16 a[42:43], v10 offset:2560
  ds_read_b128 a[44:47], v12 offset:10240
  v_mfma_f32_32x32x16_bf16 v[40:55], a[72:75], a[76:79], v[40:55]
  ds_read_b64_tr_b16 a[48:49], v10 offset:4096
  ds_read_b64_tr_b16 a[50:51], v10 offset:4608
  ds_read_b128 a[52:55], v12 offset:12288
  ds_read_b64_tr_b16 a[56:57], v10 offset:6144
  ds_read_b64_tr_b16 a[58:59], v10 offset:6656
  ds_read_b128 a[60:63], v12 offset:14336
  v_mfma_f32_32x32x16_bf16 v[40:55], a[80:83], a[84:87], v[40:55]
  v_mfma_f32_32x32x16_bf16 v[40:55], a[88:91], a[92:95], v[40:55]
  s_waitcnt lgkmcnt(12)
  s_barrier
  v_mfma_f32_32x32x16_bf16 v[40:55], a[0:3], a[4:7], v[40:55]
  ds_read_b64_tr_b16 a[64:65], v10 offset:16384
  ds_read_b64_tr_b16 a[66:67], v10 offset:16896
  ds_read_b128 a[68:71], v12 offset:24576
  ds_read_b64_tr_b16 a[72:73], v10 offset:18432
  ds_read_b64_tr_b16 a[74:75], v10 offset:18944
  ds_read_b128 a[76:79], v12 offset:26624
  v_mfma_f32_32x32x16_bf16 v[40:55], a[8:11], a[12:15], v[40:55]
  ds_read_b64_tr_b16 a[80:81], v10 offset:20480
  ds_read_b64_tr_b16 a[82:83], v10 offset:20992
  ds_read_b128 a[84:87], v12 offset:28672
  ds_read_b64_tr_b16 a[88:89], v10 offset:22528
  ds_read_b64_tr_b16 a[90:91], v10 offset:23040
  ds_read_b128 a[92:95], v12 offset:30720
  v_mfma_f32_32x32x16_bf16 v[40:55], a[16:19], a[20:23], v[40:55]
  v_mfma_f32_32x32x16_bf16 v[40:55], a[24:27], a[28:31], v[40:55]
  s_waitcnt lgkmcnt(12)
  s_barrier
  v_mfma_f32_32x32x16_bf16 v[40:55], a[32:35], a[36:39], v[40:55]
  ds_read_b64_tr_b16 a[0:1], v10 offset:32768
  ds_read_b64_tr_b16 a[2:3], v10 offset:33280
  ds_read_b128 a[4:7], v12 offset:40960
  ds_read_b64_tr_b16 a[8:9], v10 offset:34816
  ds_read_b64_tr_b16 a[10:11], v10 offset:35328
  ds_read_b128 a[12:15], v12 offset:43008
  v_mfma_f32_32x32x16_bf16 v[40:55], a[40:43], a[44:47], v[40:55]
  ds_read_b64_tr_b16 a[16:17], v10 offset:36864
  ds_read_b64_tr_b16 a[18:19], v10 offset:37376
  ds_read_b128 a[20:23], v12 offset:45056
  ds_read_b64_tr_b16 a[24:25], v10 offset:38912
  ds_read_b64_tr_b16 a[26:27], v10 offset:39424
  ds_read_b128 a[28:31], v12 offset:47104
  v_mfma_f32_32x32x16_bf16 v[40:55], a[48:51], a[52:55], v[40:55]
  v_mfma_f32_32x32x16_bf16 v[40:55], a[56:59], a[60:63], v[40:55]
  s_waitcnt lgkmcnt(12)
  s_barrier
  v_mfma_f32_32x32x16_bf16 v[40:55], a[64:67], a[68:71], v[40:55]
  ds_read_b64_tr_b16 a[32:33], v10 offset:49152
  ds_read_b64_tr_b16 a[34:35], v10 offset:49664
  ds_read_b128 a[36:39], v12 offset:57344
  ds_read_b64_tr_b16 a[40:41], v10 offset:51200
  ds_read_b64_tr_b16 a[42:43], v10 offset:51712
  ds_read_b128 a[44:47], v12 offset:59392
  v_mfma_f32_32x32x16_bf16 v[40:55], a[72:75], a[76:79], v[40:55]
  ds_read_b64_tr_b16 a[48:49], v10 offset:53248
  ds_read_b64_tr_b16 a[50:51], v10 offset:53760
  ds_read_b128 a[52:55], v12 offset:61440
  ds_read_b64_tr_b16 a[56:57], v10 offset:55296
  ds_read_b64_tr_b16 a[58:59], v10 offset:55808
  ds_read_b128 a[60:63], v12 offset:63488
  v_mfma_f32_32x32x16_bf16 v[40:55], a[80:83], a[84:87], v[40:55]
  v_mfma_f32_32x32x16_bf16 v[40:55], a[88:91], a[92:95], v[40:55]
  s_waitcnt lgkmcnt(12)
  s_barrier
  v_mfma_f32_32x32x16_bf16 v[40:55], a[0:3], a[4:7], v[40:55]
  ds_read_b64_tr_b16 a[64:65], v11 offset:0
  ds_read_b64_tr_b16 a[66:67], v11 offset:512
  ds_read_b128 a[68:71], v13 offset:8192
  ds_read_b64_tr_b16 a[72:73], v11 offset:2048
  ds_read_b64_tr_b16 a[74:75], v11 offset:2560
  ds_read_b128 a[76:79], v13 offset:10240
  v_mfma_f32_32x32x16_bf16 v[40:55], a[8:11], a[12:15], v[40:55]
  ds_read_b64_tr_b16 a[80:81], v11 offset:4096
  ds_read_b64_tr_b16 a[82:83], v11 offset:4608
  ds_read_b128 a[84:87], v13 offset:12288
  ds_read_b64_tr_b16 a[88:89], v11 offset:6144
  ds_read_b64_tr_b16 a[90:91], v11 offset:6656
  ds_read_b128 a[92:95], v13 offset:14336
  v_mfma_f32_32x32x16_bf16 v[40:55], a[16:19], a[20:23], v[40:55]
  v_mfma_f32_32x32x16_bf16 v[40:55], a[24:27], a[28:31], v[40:55]
  s_waitcnt lgkmcnt(12)
  s_barrier
  v_mfma_f32_32x32x16_bf16 v[40:55], a[32:35], a[36:39], v[40:55]
  ds_read_b64_tr_b16 a[0:1], v11 offset:16384
  ds_read_b64_tr_b16 a[2:3], v11 offset:16896
  ds_read_b128 a[4:7], v13 offset:24576
  ds_read_b64_tr_b16 a[8:9], v11 offset:18432
  ds_read_b64_tr_b16 a[10:11], v11 offset:18944
  ds_read_b128 a[12:15], v13 offset:26624
  v_mfma_f32_32x32x16_bf16 v[40:55], a[40:43], a[44:47], v[40:55]
  ds_read_b64_tr_b16 a[16:17], v11 offset:20480
  ds_read_b64_tr_b16 a[18:19], v11 offset:20992
  ds_read_b128 a[20:23], v13 offset:28672
  ds_read_b64_tr_b16 a[24:25], v11 offset:22528
  ds_read_b64_tr_b16 a[26:27], v11 offset:23040
  ds_read_b128 a[28:31], v13 offset:30720
  v_mfma_f32_32x32x16_bf16 v[40:55], a[48:51], a[52:55], v[40:55]
  v_mfma_f32_32x32x16_bf16 v[40:55], a[56:59], a[60:63], v[40:55]
  s_waitcnt lgkmcnt(12)
  s_barrier
  v_mfma_f32_32x32x16_bf16 v[40:55], a[64:67], a[68:71], v[40:55]
  ds_read_b64_tr_b16 a[32:33], v11 offset:32768
  ds_read_b64_tr_b16 a[34:35], v11 offset:33280
  ds_read_b128 a[36:39], v13 offset:40960
  ds_read_b64_tr_b16 a[40:41], v11 offset:34816
  ds_read_b64_tr_b16 a[42:43], v11 offset:35328
  ds_read_b128 a[44:47], v13 offset:43008
  v_mfma_f32_32x32x16_bf16 v[40:55], a[72:75], a[76:79], v[40:55]
  ds_read_b64_tr_b16 a[48:49], v11 offset:36864
  ds_read_b64_tr_b16 a[50:51], v11 offset:37376
  ds_read_b128 a[52:55], v13 offset:45056
  ds_read_b64_tr_b16 a[56:57], v11 offset:38912
  ds_read_b64_tr_b16 a[58:59], v11 offset:39424
  ds_read_b128 a[60:63], v13 offset:47104
  v_mfma_f32_32x32x16_bf16 v[40:55], a[80:83], a[84:87], v[40:55]
  v_mfma_f32_32x32x16_bf16 v[40:55], a[88:91], a[92:95], v[40:55]
  s_waitcnt lgkmcnt(12)
  s_barrier
  v_mfma_f32_32x32x16_bf16 v[40:55], a[0:3], a[4:7], v[40:55]
  ds_read_b64_tr_b16 a[64:65], v11 offset:49152
  ds_read_b64_tr_b16 a[66:67], v11 offset:49664
  ds_read_b128 a[68:71], v13 offset:57344
  ds_read_b64_tr_b16 a[72:73], v11 offset:51200
  ds_read_b64_tr_b16 a[74:75], v11 offset:51712
  ds_read_b128 a[76:79], v13 offset:59392
  v_mfma_f32_32x32x16_bf16 v[40:55], a[8:11], a[12:15], v[40:55]
  ds_read_b64_tr_b16 a[80:81], v11 offset:53248
  ds_read_b64_tr_b16 a[82:83], v11 offset:53760
  ds_read_b128 a[84:87], v13 offset:61440
  ds_read_b64_tr_b16 a[88:89], v11 offset:55296
  ds_read_b64_tr_b16 a[90:91], v11 offset:55808
  ds_read_b128 a[92:95], v13 offset:63488
  v_mfma_f32_32x32x16_bf16 v[40:55], a[16:19], a[20:23], v[40:55]
  v_mfma_f32_32x32x16_bf16 v[40:55], a[24:27], a[28:31], v[40:55]
  s_waitcnt lgkmcnt(12)
  s_barrier
  s_lshl_b32 s4, s86, 1
  s_lshr_b32 s5, s79, 1
  s_add_u32 s4, s4, s5
  s_mul_i32 s4, s4, 88
  s_lshl_b32 s5, s87, 2
  s_and_b32 s6, s79, 1
  s_lshl_b32 s6, s6, 1
  s_add_u32 s5, s5, s6
  s_add_u32 s4, s4, s5
  s_lshl_b32 s4, s4, 10
  s_add_u32 s60, s4, 2097152
  s_cmp_ge_u32 s5, 86
  s_cselect_b32 s61, 0, -1
  v_mov_b32 v88, 0xbdd2d3e8
  v_mov_b32 v90, 0xc0135761
  v_mov_b32 v92, 1.0
  v_lshlrev_b32 v94, 4, v1
  v_mfma_f32_32x32x16_bf16 v[40:55], a[32:35], a[36:39], v[40:55]
  ds_read_b64_tr_b16 a[0:1], v10 offset:0
  ds_read_b64_tr_b16 a[2:3], v10 offset:512
  ds_read_b128 a[4:7], v12 offset:8192
  ds_read_b64_tr_b16 a[8:9], v10 offset:2048
  ds_read_b64_tr_b16 a[10:11], v10 offset:2560
  ds_read_b128 a[12:15], v12 offset:10240
  v_mfma_f32_32x32x16_bf16 v[40:55], a[40:43], a[44:47], v[40:55]
  ds_read_b64_tr_b16 a[16:17], v10 offset:4096
  ds_read_b64_tr_b16 a[18:19], v10 offset:4608
  ds_read_b128 a[20:23], v12 offset:12288
  ds_read_b64_tr_b16 a[24:25], v10 offset:6144
  ds_read_b64_tr_b16 a[26:27], v10 offset:6656
  ds_read_b128 a[28:31], v12 offset:14336
  v_mfma_f32_32x32x16_bf16 v[40:55], a[48:51], a[52:55], v[40:55]
  v_mfma_f32_32x32x16_bf16 v[40:55], a[56:59], a[60:63], v[40:55]
  s_waitcnt lgkmcnt(12)
  s_barrier
  v_mfma_f32_32x32x16_bf16 v[40:55], a[64:67], a[68:71], v[40:55]
  ds_read_b64_tr_b16 a[32:33], v10 offset:16384
  ds_read_b64_tr_b16 a[34:35], v10 offset:16896
  ds_read_b128 a[36:39], v12 offset:24576
  ds_read_b64_tr_b16 a[40:41], v10 offset:18432
  ds_read_b64_tr_b16 a[42:43], v10 offset:18944
  ds_read_b128 a[44:47], v12 offset:26624
  v_mfma_f32_32x32x16_bf16 v[40:55], a[72:75], a[76:79], v[40:55]
  ds_read_b64_tr_b16 a[48:49], v10 offset:20480
  ds_read_b64_tr_b16 a[50:51], v10 offset:20992
  ds_read_b128 a[52:55], v12 offset:28672
  ds_read_b64_tr_b16 a[56:57], v10 offset:22528
  ds_read_b64_tr_b16 a[58:59], v10 offset:23040
  ds_read_b128 a[60:63], v12 offset:30720
  v_mfma_f32_32x32x16_bf16 v[40:55], a[80:83], a[84:87], v[40:55]
  v_mfma_f32_32x32x16_bf16 v[40:55], a[88:91], a[92:95], v[40:55]
  s_waitcnt lgkmcnt(12)
  s_barrier
  v_mfma_f32_32x32x16_bf16 v[40:55], a[0:3], a[4:7], v[40:55]
  ds_read_b64_tr_b16 a[64:65], v10 offset:32768
  ds_read_b64_tr_b16 a[66:67], v10 offset:33280
  ds_read_b128 a[68:71], v12 offset:40960
  ds_read_b64_tr_b16 a[72:73], v10 offset:34816
  ds_read_b64_tr_b16 a[74:75], v10 offset:35328
  ds_read_b128 a[76:79], v12 offset:43008
  v_mfma_f32_32x32x16_bf16 v[40:55], a[8:11], a[12:15], v[40:55]
  ds_read_b64_tr_b16 a[80:81], v10 offset:36864
  ds_read_b64_tr_b16 a[82:83], v10 offset:37376
  ds_read_b128 a[84:87], v12 offset:45056
  ds_read_b64_tr_b16 a[88:89], v10 offset:38912
  ds_read_b64_tr_b16 a[90:91], v10 offset:39424
  ds_read_b128 a[92:95], v12 offset:47104
  v_mfma_f32_32x32x16_bf16 v[40:55], a[16:19], a[20:23], v[40:55]
  v_mfma_f32_32x32x16_bf16 v[40:55], a[24:27], a[28:31], v[40:55]
  s_waitcnt lgkmcnt(12)
  s_barrier
  v_mfma_f32_32x32x16_bf16 v[40:55], a[32:35], a[36:39], v[40:55]
  ds_read_b64_tr_b16 a[0:1], v10 offset:49152
  ds_read_b64_tr_b16 a[2:3], v10 offset:49664
  ds_read_b128 a[4:7], v12 offset:57344
  ds_read_b64_tr_b16 a[8:9], v10 offset:51200
  ds_read_b64_tr_b16 a[10:11], v10 offset:51712
  ds_read_b128 a[12:15], v12 offset:59392
  v_mfma_f32_32x32x16_bf16 v[40:55], a[40:43], a[44:47], v[40:55]
  ds_read_b64_tr_b16 a[16:17], v10 offset:53248
  ds_read_b64_tr_b16 a[18:19], v10 offset:53760
  ds_read_b128 a[20:23], v12 offset:61440
  ds_read_b64_tr_b16 a[24:25], v10 offset:55296
  ds_read_b64_tr_b16 a[26:27], v10 offset:55808
  ds_read_b128 a[28:31], v12 offset:63488
  v_mfma_f32_32x32x16_bf16 v[40:55], a[48:51], a[52:55], v[40:55]
  v_mfma_f32_32x32x16_bf16 v[40:55], a[56:59], a[60:63], v[40:55]
  s_waitcnt lgkmcnt(12)
  s_barrier
  v_mfma_f32_32x32x16_bf16 v[40:55], a[64:67], a[68:71], v[40:55]
  ds_read_b64_tr_b16 a[32:33], v11 offset:0
  ds_read_b64_tr_b16 a[34:35], v11 offset:512
  ds_read_b128 a[36:39], v13 offset:8192
  ds_read_b64_tr_b16 a[40:41], v11 offset:2048
  ds_read_b64_tr_b16 a[42:43], v11 offset:2560
  ds_read_b128 a[44:47], v13 offset:10240
  v_mfma_f32_32x32x16_bf16 v[40:55], a[72:75], a[76:79], v[40:55]
  ds_read_b64_tr_b16 a[48:49], v11 offset:4096
  ds_read_b64_tr_b16 a[50:51], v11 offset:4608
  ds_read_b128 a[52:55], v13 offset:12288
  ds_read_b64_tr_b16 a[56:57], v11 offset:6144
  ds_read_b64_tr_b16 a[58:59], v11 offset:6656
  ds_read_b128 a[60:63], v13 offset:14336
  v_mfma_f32_32x32x16_bf16 v[40:55], a[80:83], a[84:87], v[40:55]
  v_mfma_f32_32x32x16_bf16 v[40:55], a[88:91], a[92:95], v[40:55]
  s_waitcnt lgkmcnt(12)
  v_mfma_f32_32x32x16_bf16 v[40:55], a[0:3], a[4:7], v[40:55]
  v_mfma_f32_32x32x16_bf16 v[40:55], a[8:11], a[12:15], v[40:55]
  v_mfma_f32_32x32x16_bf16 v[40:55], a[16:19], a[20:23], v[40:55]
  v_mfma_f32_32x32x16_bf16 v[40:55], a[24:27], a[28:31], v[40:55]
  s_waitcnt lgkmcnt(0)
  s_barrier
  v_mfma_f32_32x32x16_bf16 v[40:55], a[32:35], a[36:39], v[40:55]
  v_mfma_f32_32x32x16_bf16 v[40:55], a[40:43], a[44:47], v[40:55]
  v_mfma_f32_32x32x16_bf16 v[40:55], a[48:51], a[52:55], v[40:55]
  v_mfma_f32_32x32x16_bf16 v[40:55], a[56:59], a[60:63], v[40:55]
  s_nop 11
  v_pk_mul_f32 v[56:57], v[40:41], v[40:41]
  v_pk_mul_f32 v[58:59], v[42:43], v[42:43]
  v_pk_mul_f32 v[60:61], v[44:45], v[44:45]
  v_pk_mul_f32 v[62:63], v[46:47], v[46:47]
  v_pk_mul_f32 v[64:65], v[48:49], v[48:49]
  v_pk_mul_f32 v[66:67], v[50:51], v[50:51]
  v_pk_mul_f32 v[68:69], v[52:53], v[52:53]
  v_pk_mul_f32 v[70:71], v[54:55], v[54:55]
  v_pk_fma_f32 v[56:57], v[56:57], v[88:89], v[90:91] op_sel_hi:[1,0,0]
  v_pk_fma_f32 v[58:59], v[58:59], v[88:89], v[90:91] op_sel_hi:[1,0,0]
  v_pk_fma_f32 v[60:61], v[60:61], v[88:89], v[90:91] op_sel_hi:[1,0,0]
  v_pk_fma_f32 v[62:63], v[62:63], v[88:89], v[90:91] op_sel_hi:[1,0,0]
  v_pk_fma_f32 v[64:65], v[64:65], v[88:89], v[90:91] op_sel_hi:[1,0,0]
  v_pk_fma_f32 v[66:67], v[66:67], v[88:89], v[90:91] op_sel_hi:[1,0,0]
  v_pk_fma_f32 v[68:69], v[68:69], v[88:89], v[90:91] op_sel_hi:[1,0,0]
  v_pk_fma_f32 v[70:71], v[70:71], v[88:89], v[90:91] op_sel_hi:[1,0,0]
  v_pk_mul_f32 v[56:57], v[56:57], v[40:41]
  v_pk_mul_f32 v[58:59], v[58:59], v[42:43]
  v_pk_mul_f32 v[60:61], v[60:61], v[44:45]
  v_pk_mul_f32 v[62:63], v[62:63], v[46:47]
  v_pk_mul_f32 v[64:65], v[64:65], v[48:49]
  v_pk_mul_f32 v[66:67], v[66:67], v[50:51]
  v_pk_mul_f32 v[68:69], v[68:69], v[52:53]
  v_pk_mul_f32 v[70:71], v[70:71], v[54:55]
  v_exp_f32 v56, v56
  v_exp_f32 v57, v57
  v_exp_f32 v58, v58
  v_exp_f32 v59, v59
  v_exp_f32 v60, v60
  v_exp_f32 v61, v61
  v_exp_f32 v62, v62
  v_exp_f32 v63, v63
  v_exp_f32 v64, v64
  v_exp_f32 v65, v65
  v_exp_f32 v66, v66
  v_exp_f32 v67, v67
  v_exp_f32 v68, v68
  v_exp_f32 v69, v69
  v_exp_f32 v70, v70
  v_exp_f32 v71, v71
  v_pk_add_f32 v[56:57], v[56:57], v[92:93] op_sel_hi:[1,0]
  v_pk_add_f32 v[58:59], v[58:59], v[92:93] op_sel_hi:[1,0]
  v_pk_add_f32 v[60:61], v[60:61], v[92:93] op_sel_hi:[1,0]
  v_pk_add_f32 v[62:63], v[62:63], v[92:93] op_sel_hi:[1,0]
  v_pk_add_f32 v[64:65], v[64:65], v[92:93] op_sel_hi:[1,0]
  v_pk_add_f32 v[66:67], v[66:67], v[92:93] op_sel_hi:[1,0]
  v_pk_add_f32 v[68:69], v[68:69], v[92:93] op_sel_hi:[1,0]
  v_pk_add_f32 v[70:71], v[70:71], v[92:93] op_sel_hi:[1,0]
  v_rcp_f32 v56, v56
  v_rcp_f32 v57, v57
  v_rcp_f32 v58, v58
  v_rcp_f32 v59, v59
  v_rcp_f32 v60, v60
  v_rcp_f32 v61, v61
  v_rcp_f32 v62, v62
  v_rcp_f32 v63, v63
  v_rcp_f32 v64, v64
  v_rcp_f32 v65, v65
  v_rcp_f32 v66, v66
  v_rcp_f32 v67, v67
  v_rcp_f32 v68, v68
  v_rcp_f32 v69, v69
  v_rcp_f32 v70, v70
  v_rcp_f32 v71, v71
  v_pk_mul_f32 v[40:41], v[40:41], v[56:57]
  v_pk_mul_f32 v[42:43], v[42:43], v[58:59]
  v_pk_mul_f32 v[44:45], v[44:45], v[60:61]
  v_pk_mul_f32 v[46:47], v[46:47], v[62:63]
  v_pk_mul_f32 v[48:49], v[48:49], v[64:65]
  v_pk_mul_f32 v[50:51], v[50:51], v[66:67]
  v_pk_mul_f32 v[52:53], v[52:53], v[68:69]
  v_pk_mul_f32 v[54:55], v[54:55], v[70:71]
  v_cvt_pk_bf16_f32 v24, v40, v41
  v_cvt_pk_bf16_f32 v25, v42, v43
  v_cvt_pk_bf16_f32 v26, v44, v45
  v_cvt_pk_bf16_f32 v27, v46, v47
  v_cvt_pk_bf16_f32 v28, v48, v49
  v_cvt_pk_bf16_f32 v29, v50, v51
  v_cvt_pk_bf16_f32 v30, v52, v53
  v_cvt_pk_bf16_f32 v31, v54, v55
  s_cmp_lg_u32 s61, 0
  s_cbranch_scc1 L_uz_14
  v_mov_b32 v24, 0
  v_mov_b32 v25, 0
  v_mov_b32 v26, 0
  v_mov_b32 v27, 0
  v_mov_b32 v28, 0
  v_mov_b32 v29, 0
  v_mov_b32 v30, 0
  v_mov_b32 v31, 0
L_uz_14:
  buffer_store_dwordx4 v[24:27], v94, s[28:31], s60 offen sc1
  buffer_store_dwordx4 v[28:31], v94, s[28:31], s60 offen offset:1024 sc1
L_c_merge:
  s_cmp_lg_u32 s85, 0
  s_cbranch_scc1 L_up_20
  s_waitcnt vmcnt(0)
  v_mov_b32 v5, 162832
  v_mov_b32 v6, 1
  s_mov_b64 exec, 1
  ds_add_rtn_u32 v7, v5, v6
  s_waitcnt lgkmcnt(0)
  v_readfirstlane_b32 s4, v7
  s_nop 3
  s_cmp_lg_u32 s4, 3
  s_cbranch_scc1 L_el_21
  v_mov_b32 v5, s94
  buffer_store_dword v6, v5, s[28:31], 0 offen sc1
L_el_21:
  s_mov_b64 exec, -1
L_up_20:
  s_lshl_b32 s4, s89, 6
  s_lshr_b32 s5, s79, 1
  s_lshl_b32 s5, s5, 5
  s_add_u32 s4, s4, s5
  v_add_u32 v5, s4, v2
  v_lshlrev_b32 v6, 2, v5
  v_add_u32 v6, 6422528, v6
  v_lshlrev_b32 v5, 1, v5
  buffer_load_dword v14, v6, s[28:31], 0 offen sc1
  buffer_load_ushort v15, v5, s[44:47], 0 offen
  s_lshr_b32 s6, s79, 1
  s_lshl_b32 s6, s6, 6
  v_bfe_u32 v5, v1, 2, 2
  v_lshl_add_u32 v6, v3, 2, v5
  v_lshlrev_b32 v6, 7, v6
  v_lshrrev_b32 v5, 1, v5
  v_lshlrev_b32 v5, 6, v5
  v_xor_b32 v5, s6, v5
  v_add_u32 v6, v6, v5
  v_bfe_u32 v5, v1, 4, 1
  v_lshl_add_u32 v6, v5, 5, v6
  v_and_b32 v5, 3, v1
  v_lshl_add_u32 v10, v5, 3, v6
  v_add_u32 v11, 65536, v10
  s_and_b32 s4, s79, 1
  s_lshl_b32 s4, s4, 12
  v_lshlrev_b32 v5, 4, v1
  v_add_u32 v12, s4, v5
  v_add_u32 v13, 65536, v12
  s_barrier
  s_waitcnt vmcnt(0)
  v_lshlrev_b32 v15, 16, v15
  v_mov_b32 v40, v15
  v_mov_b32 v41, v15
  v_mov_b32 v42, v15
  v_mov_b32 v43, v15
  v_mov_b32 v44, v15
  v_mov_b32 v45, v15
  v_mov_b32 v46, v15
  v_mov_b32 v47, v15
  v_mov_b32 v48, v15
  v_mov_b32 v49, v15
  v_mov_b32 v50, v15
  v_mov_b32 v51, v15
  v_mov_b32 v52, v15
  v_mov_b32 v53, v15
  v_mov_b32 v54, v15
  v_mov_b32 v55, v15
  ds_read_b64_tr_b16 a[0:1], v11 offset:16384
  ds_read_b64_tr_b16 a[2:3], v11 offset:17408
  ds_read_b128 a[4:7], v13 offset:24576
  ds_read_b64_tr_b16 a[8:9], v11 offset:18432
  ds_read_b64_tr_b16 a[10:11], v11 offset:19456
  ds_read_b128 a[12:15], v13 offset:25600
  ds_read_b64_tr_b16 a[16:17], v11 offset:20480
  ds_read_b64_tr_b16 a[18:19], v11 offset:21504
  ds_read_b128 a[20:23], v13 offset:26624
  ds_read_b64_tr_b16 a[24:25], v11 offset:22528
  ds_read_b64_tr_b16 a[26:27], v11 offset:23552
  ds_read_b128 a[28:31], v13 offset:27648
  s_barrier
  ds_read_b64_tr_b16 a[32:33], v11 offset:32768
  ds_read_b64_tr_b16 a[34:35], v11 offset:33792
  ds_read_b128 a[36:39], v13 offset:40960
  ds_read_b64_tr_b16 a[40:41], v11 offset:34816
  ds_read_b64_tr_b16 a[42:43], v11 offset:35840
  ds_read_b128 a[44:47], v13 offset:41984
  ds_read_b64_tr_b16 a[48:49], v11 offset:36864
  ds_read_b64_tr_b16 a[50:51], v11 offset:37888
  ds_read_b128 a[52:55], v13 offset:43008
  ds_read_b64_tr_b16 a[56:57], v11 offset:38912
  ds_read_b64_tr_b16 a[58:59], v11 offset:39936
  ds_read_b128 a[60:63], v13 offset:44032
  s_waitcnt lgkmcnt(12)
  s_barrier
  v_mfma_f32_32x32x16_bf16 v[40:55], a[4:7], a[0:3], v[40:55]
  ds_read_b64_tr_b16 a[64:65], v11 offset:49152
  ds_read_b64_tr_b16 a[66:67], v11 offset:50176
  ds_read_b128 a[68:71], v13 offset:57344
  ds_read_b64_tr_b16 a[72:73], v11 offset:51200
  ds_read_b64_tr_b16 a[74:75], v11 offset:52224
  ds_read_b128 a[76:79], v13 offset:58368
  v_mfma_f32_32x32x16_bf16 v[40:55], a[12:15], a[8:11], v[40:55]
  ds_read_b64_tr_b16 a[80:81], v11 offset:53248
  ds_read_b64_tr_b16 a[82:83], v11 offset:54272
  ds_read_b128 a[84:87], v13 offset:59392
  ds_read_b64_tr_b16 a[88:89], v11 offset:55296
  ds_read_b64_tr_b16 a[90:91], v11 offset:56320
  ds_read_b128 a[92:95], v13 offset:60416
  v_mfma_f32_32x32x16_bf16 v[40:55], a[20:23], a[16:19], v[40:55]
  v_mfma_f32_32x32x16_bf16 v[40:55], a[28:31], a[24:27], v[40:55]
  s_waitcnt lgkmcnt(12)
  s_barrier
  v_mfma_f32_32x32x16_bf16 v[40:55], a[36:39], a[32:35], v[40:55]
  ds_read_b64_tr_b16 a[0:1], v10 offset:0
  ds_read_b64_tr_b16 a[2:3], v10 offset:1024
  ds_read_b128 a[4:7], v12 offset:8192
  ds_read_b64_tr_b16 a[8:9], v10 offset:2048
  ds_read_b64_tr_b16 a[10:11], v10 offset:3072
  ds_read_b128 a[12:15], v12 offset:9216
  v_mfma_f32_32x32x16_bf16 v[40:55], a[44:47], a[40:43], v[40:55]
  ds_read_b64_tr_b16 a[16:17], v10 offset:4096
  ds_read_b64_tr_b16 a[18:19], v10 offset:5120
  ds_read_b128 a[20:23], v12 offset:10240
  ds_read_b64_tr_b16 a[24:25], v10 offset:6144
  ds_read_b64_tr_b16 a[26:27], v10 offset:7168
  ds_read_b128 a[28:31], v12 offset:11264
  v_mfma_f32_32x32x16_bf16 v[40:55], a[52:55], a[48:51], v[40:55]
  v_mfma_f32_32x32x16_bf16 v[40:55], a[60:63], a[56:59], v[40:55]
  s_waitcnt lgkmcnt(12)
  s_barrier
  v_mfma_f32_32x32x16_bf16 v[40:55], a[68:71], a[64:67], v[40:55]
  ds_read_b64_tr_b16 a[32:33], v10 offset:16384
  ds_read_b64_tr_b16 a[34:35], v10 offset:17408
  ds_read_b128 a[36:39], v12 offset:24576
  ds_read_b64_tr_b16 a[40:41], v10 offset:18432
  ds_read_b64_tr_b16 a[42:43], v10 offset:19456
  ds_read_b128 a[44:47], v12 offset:25600
  v_mfma_f32_32x32x16_bf16 v[40:55], a[76:79], a[72:75], v[40:55]
  ds_read_b64_tr_b16 a[48:49], v10 offset:20480
  ds_read_b64_tr_b16 a[50:51], v10 offset:21504
  ds_read_b128 a[52:55], v12 offset:26624
  ds_read_b64_tr_b16 a[56:57], v10 offset:22528
  ds_read_b64_tr_b16 a[58:59], v10 offset:23552
  ds_read_b128 a[60:63], v12 offset:27648
  v_mfma_f32_32x32x16_bf16 v[40:55], a[84:87], a[80:83], v[40:55]
  v_mfma_f32_32x32x16_bf16 v[40:55], a[92:95], a[88:91], v[40:55]
  s_waitcnt lgkmcnt(12)
  s_barrier
  v_mfma_f32_32x32x16_bf16 v[40:55], a[4:7], a[0:3], v[40:55]
  ds_read_b64_tr_b16 a[64:65], v10 offset:32768
  ds_read_b64_tr_b16 a[66:67], v10 offset:33792
  ds_read_b128 a[68:71], v12 offset:40960
  ds_read_b64_tr_b16 a[72:73], v10 offset:34816
  ds_read_b64_tr_b16 a[74:75], v10 offset:35840
  ds_read_b128 a[76:79], v12 offset:41984
  v_mfma_f32_32x32x16_bf16 v[40:55], a[12:15], a[8:11], v[40:55]
  ds_read_b64_tr_b16 a[80:81], v10 offset:36864
  ds_read_b64_tr_b16 a[82:83], v10 offset:37888
  ds_read_b128 a[84:87], v12 offset:43008
  ds_read_b64_tr_b16 a[88:89], v10 offset:38912
  ds_read_b64_tr_b16 a[90:91], v10 offset:39936
  ds_read_b128 a[92:95], v12 offset:44032
  v_mfma_f32_32x32x16_bf16 v[40:55], a[20:23], a[16:19], v[40:55]
  v_mfma_f32_32x32x16_bf16 v[40:55], a[28:31], a[24:27], v[40:55]
  s_waitcnt lgkmcnt(12)
  s_barrier
  v_mfma_f32_32x32x16_bf16 v[40:55], a[36:39], a[32:35], v[40:55]
  ds_read_b64_tr_b16 a[0:1], v10 offset:49152
  ds_read_b64_tr_b16 a[2:3], v10 offset:50176
  ds_read_b128 a[4:7], v12 offset:57344
  ds_read_b64_tr_b16 a[8:9], v10 offset:51200
  ds_read_b64_tr_b16 a[10:11], v10 offset:52224
  ds_read_b128 a[12:15], v12 offset:58368
  v_mfma_f32_32x32x16_bf16 v[40:55], a[44:47], a[40:43], v[40:55]
  ds_read_b64_tr_b16 a[16:17], v10 offset:53248
  ds_read_b64_tr_b16 a[18:19], v10 offset:54272
  ds_read_b128 a[20:23], v12 offset:59392
  ds_read_b64_tr_b16 a[24:25], v10 offset:55296
  ds_read_b64_tr_b16 a[26:27], v10 offset:56320
  ds_read_b128 a[28:31], v12 offset:60416
  v_mfma_f32_32x32x16_bf16 v[40:55], a[52:55], a[48:51], v[40:55]
  v_mfma_f32_32x32x16_bf16 v[40:55], a[60:63], a[56:59], v[40:55]
  s_waitcnt lgkmcnt(12)
  s_barrier
  v_mfma_f32_32x32x16_bf16 v[40:55], a[68:71], a[64:67], v[40:55]
  ds_read_b64_tr_b16 a[32:33], v11 offset:0
  ds_read_b64_tr_b16 a[34:35], v11 offset:1024
  ds_read_b128 a[36:39], v13 offset:8192
  ds_read_b64_tr_b16 a[40:41], v11 offset:2048
  ds_read_b64_tr_b16 a[42:43], v11 offset:3072
  ds_read_b128 a[44:47], v13 offset:9216
  v_mfma_f32_32x32x16_bf16 v[40:55], a[76:79], a[72:75], v[40:55]
  ds_read_b64_tr_b16 a[48:49], v11 offset:4096
  ds_read_b64_tr_b16 a[50:51], v11 offset:5120
  ds_read_b128 a[52:55], v13 offset:10240
  ds_read_b64_tr_b16 a[56:57], v11 offset:6144
  ds_read_b64_tr_b16 a[58:59], v11 offset:7168
  ds_read_b128 a[60:63], v13 offset:11264
  v_mfma_f32_32x32x16_bf16 v[40:55], a[84:87], a[80:83], v[40:55]
  v_mfma_f32_32x32x16_bf16 v[40:55], a[92:95], a[88:91], v[40:55]
  s_waitcnt lgkmcnt(12)
  s_barrier
  v_mfma_f32_32x32x16_bf16 v[40:55], a[4:7], a[0:3], v[40:55]
  ds_read_b64_tr_b16 a[64:65], v11 offset:16384
  ds_read_b64_tr_b16 a[66:67], v11 offset:17408
  ds_read_b128 a[68:71], v13 offset:24576
  ds_read_b64_tr_b16 a[72:73], v11 offset:18432
  ds_read_b64_tr_b16 a[74:75], v11 offset:19456
  ds_read_b128 a[76:79], v13 offset:25600
  v_mfma_f32_32x32x16_bf16 v[40:55], a[12:15], a[8:11], v[40:55]
  ds_read_b64_tr_b16 a[80:81], v11 offset:20480
  ds_read_b64_tr_b16 a[82:83], v11 offset:21504
  ds_read_b128 a[84:87], v13 offset:26624
  ds_read_b64_tr_b16 a[88:89], v11 offset:22528
  ds_read_b64_tr_b16 a[90:91], v11 offset:23552
  ds_read_b128 a[92:95], v13 offset:27648
  v_mfma_f32_32x32x16_bf16 v[40:55], a[20:23], a[16:19], v[40:55]
  v_mfma_f32_32x32x16_bf16 v[40:55], a[28:31], a[24:27], v[40:55]
  s_waitcnt lgkmcnt(12)
  s_barrier
  v_mfma_f32_32x32x16_bf16 v[40:55], a[36:39], a[32:35], v[40:55]
  ds_read_b64_tr_b16 a[0:1], v11 offset:32768
  ds_read_b64_tr_b16 a[2:3], v11 offset:33792
  ds_read_b128 a[4:7], v13 offset:40960
  ds_read_b64_tr_b16 a[8:9], v11 offset:34816
  ds_read_b64_tr_b16 a[10:11], v11 offset:35840
  ds_read_b128 a[12:15], v13 offset:41984
  v_mfma_f32_32x32x16_bf16 v[40:55], a[44:47], a[40:43], v[40:55]
  ds_read_b64_tr_b16 a[16:17], v11 offset:36864
  ds_read_b64_tr_b16 a[18:19], v11 offset:37888
  ds_read_b128 a[20:23], v13 offset:43008
  ds_read_b64_tr_b16 a[24:25], v11 offset:38912
  ds_read_b64_tr_b16 a[26:27], v11 offset:39936
  ds_read_b128 a[28:31], v13 offset:44032
  v_mfma_f32_32x32x16_bf16 v[40:55], a[52:55], a[48:51], v[40:55]
  v_mfma_f32_32x32x16_bf16 v[40:55], a[60:63], a[56:59], v[40:55]
  s_waitcnt lgkmcnt(12)
  s_barrier
  v_mfma_f32_32x32x16_bf16 v[40:55], a[68:71], a[64:67], v[40:55]
  ds_read_b64_tr_b16 a[32:33], v11 offset:49152
  ds_read_b64_tr_b16 a[34:35], v11 offset:50176
  ds_read_b128 a[36:39], v13 offset:57344
  ds_read_b64_tr_b16 a[40:41], v11 offset:51200
  ds_read_b64_tr_b16 a[42:43], v11 offset:52224
  ds_read_b128 a[44:47], v13 offset:58368
  v_mfma_f32_32x32x16_bf16 v[40:55], a[76:79], a[72:75], v[40:55]
  ds_read_b64_tr_b16 a[48:49], v11 offset:53248
  ds_read_b64_tr_b16 a[50:51], v11 offset:54272
  ds_read_b128 a[52:55], v13 offset:59392
  ds_read_b64_tr_b16 a[56:57], v11 offset:55296
  ds_read_b64_tr_b16 a[58:59], v11 offset:56320
  ds_read_b128 a[60:63], v13 offset:60416
  v_mfma_f32_32x32x16_bf16 v[40:55], a[84:87], a[80:83], v[40:55]
  v_mfma_f32_32x32x16_bf16 v[40:55], a[92:95], a[88:91], v[40:55]
  s_waitcnt lgkmcnt(12)
  s_barrier
  v_mfma_f32_32x32x16_bf16 v[40:55], a[4:7], a[0:3], v[40:55]
  ds_read_b64_tr_b16 a[64:65], v10 offset:0
  ds_read_b64_tr_b16 a[66:67], v10 offset:1024
  ds_read_b128 a[68:71], v12 offset:8192
  ds_read_b64_tr_b16 a[72:73], v10 offset:2048
  ds_read_b64_tr_b16 a[74:75], v10 offset:3072
  ds_read_b128 a[76:79], v12 offset:9216
  v_mfma_f32_32x32x16_bf16 v[40:55], a[12:15], a[8:11], v[40:55]
  ds_read_b64_tr_b16 a[80:81], v10 offset:4096
  ds_read_b64_tr_b16 a[82:83], v10 offset:5120
  ds_read_b128 a[84:87], v12 offset:10240
  ds_read_b64_tr_b16 a[88:89], v10 offset:6144
  ds_read_b64_tr_b16 a[90:91], v10 offset:7168
  ds_read_b128 a[92:95], v12 offset:11264
  v_mfma_f32_32x32x16_bf16 v[40:55], a[20:23], a[16:19], v[40:55]
  v_mfma_f32_32x32x16_bf16 v[40:55], a[28:31], a[24:27], v[40:55]
  s_waitcnt lgkmcnt(12)
  s_barrier
  v_mfma_f32_32x32x16_bf16 v[40:55], a[36:39], a[32:35], v[40:55]
  ds_read_b64_tr_b16 a[0:1], v10 offset:16384
  ds_read_b64_tr_b16 a[2:3], v10 offset:17408
  ds_read_b128 a[4:7], v12 offset:24576
  ds_read_b64_tr_b16 a[8:9], v10 offset:18432
  ds_read_b64_tr_b16 a[10:11], v10 offset:19456
  ds_read_b128 a[12:15], v12 offset:25600
  v_mfma_f32_32x32x16_bf16 v[40:55], a[44:47], a[40:43], v[40:55]
  ds_read_b64_tr_b16 a[16:17], v10 offset:20480
  ds_read_b64_tr_b16 a[18:19], v10 offset:21504
  ds_read_b128 a[20:23], v12 offset:26624
  ds_read_b64_tr_b16 a[24:25], v10 offset:22528
  ds_read_b64_tr_b16 a[26:27], v10 offset:23552
  ds_read_b128 a[28:31], v12 offset:27648
  v_mfma_f32_32x32x16_bf16 v[40:55], a[52:55], a[48:51], v[40:55]
  v_mfma_f32_32x32x16_bf16 v[40:55], a[60:63], a[56:59], v[40:55]
  s_waitcnt lgkmcnt(12)
  s_barrier
  v_mfma_f32_32x32x16_bf16 v[40:55], a[68:71], a[64:67], v[40:55]
  ds_read_b64_tr_b16 a[32:33], v10 offset:32768
  ds_read_b64_tr_b16 a[34:35], v10 offset:33792
  ds_read_b128 a[36:39], v12 offset:40960
  ds_read_b64_tr_b16 a[40:41], v10 offset:34816
  ds_read_b64_tr_b16 a[42:43], v10 offset:35840
  ds_read_b128 a[44:47], v12 offset:41984
  v_mfma_f32_32x32x16_bf16 v[40:55], a[76:79], a[72:75], v[40:55]
  ds_read_b64_tr_b16 a[48:49], v10 offset:36864
  ds_read_b64_tr_b16 a[50:51], v10 offset:37888
  ds_read_b128 a[52:55], v12 offset:43008
  ds_read_b64_tr_b16 a[56:57], v10 offset:38912
  ds_read_b64_tr_b16 a[58:59], v10 offset:39936
  ds_read_b128 a[60:63], v12 offset:44032
  v_mfma_f32_32x32x16_bf16 v[40:55], a[84:87], a[80:83], v[40:55]
  v_mfma_f32_32x32x16_bf16 v[40:55], a[92:95], a[88:91], v[40:55]
  s_waitcnt lgkmcnt(12)
  s_barrier
  v_mfma_f32_32x32x16_bf16 v[40:55], a[4:7], a[0:3], v[40:55]
  ds_read_b64_tr_b16 a[64:65], v10 offset:49152
  ds_read_b64_tr_b16 a[66:67], v10 offset:50176
  ds_read_b128 a[68:71], v12 offset:57344
  ds_read_b64_tr_b16 a[72:73], v10 offset:51200
  ds_read_b64_tr_b16 a[74:75], v10 offset:52224
  ds_read_b128 a[76:79], v12 offset:58368
  v_mfma_f32_32x32x16_bf16 v[40:55], a[12:15], a[8:11], v[40:55]
  ds_read_b64_tr_b16 a[80:81], v10 offset:53248
  ds_read_b64_tr_b16 a[82:83], v10 offset:54272
  ds_read_b128 a[84:87], v12 offset:59392
  ds_read_b64_tr_b16 a[88:89], v10 offset:55296
  ds_read_b64_tr_b16 a[90:91], v10 offset:56320
  ds_read_b128 a[92:95], v12 offset:60416
  v_mfma_f32_32x32x16_bf16 v[40:55], a[20:23], a[16:19], v[40:55]
  v_mfma_f32_32x32x16_bf16 v[40:55], a[28:31], a[24:27], v[40:55]
  s_waitcnt lgkmcnt(12)
  s_barrier
  v_mfma_f32_32x32x16_bf16 v[40:55], a[36:39], a[32:35], v[40:55]
  ds_read_b64_tr_b16 a[0:1], v11 offset:0
  ds_read_b64_tr_b16 a[2:3], v11 offset:1024
  ds_read_b128 a[4:7], v13 offset:8192
  ds_read_b64_tr_b16 a[8:9], v11 offset:2048
  ds_read_b64_tr_b16 a[10:11], v11 offset:3072
  ds_read_b128 a[12:15], v13 offset:9216
  v_mfma_f32_32x32x16_bf16 v[40:55], a[44:47], a[40:43], v[40:55]
  ds_read_b64_tr_b16 a[16:17], v11 offset:4096
  ds_read_b64_tr_b16 a[18:19], v11 offset:5120
  ds_read_b128 a[20:23], v13 offset:10240
  ds_read_b64_tr_b16 a[24:25], v11 offset:6144
  ds_read_b64_tr_b16 a[26:27], v11 offset:7168
  ds_read_b128 a[28:31], v13 offset:11264
  v_mfma_f32_32x32x16_bf16 v[40:55], a[52:55], a[48:51], v[40:55]
  v_mfma_f32_32x32x16_bf16 v[40:55], a[60:63], a[56:59], v[40:55]
  s_waitcnt lgkmcnt(12)
  s_barrier
  v_mfma_f32_32x32x16_bf16 v[40:55], a[68:71], a[64:67], v[40:55]
  ds_read_b64_tr_b16 a[32:33], v11 offset:16384
  ds_read_b64_tr_b16 a[34:35], v11 offset:17408
  ds_read_b128 a[36:39], v13 offset:24576
  ds_read_b64_tr_b16 a[40:41], v11 offset:18432
  ds_read_b64_tr_b16 a[42:43], v11 offset:19456
  ds_read_b128 a[44:47], v13 offset:25600
  v_mfma_f32_32x32x16_bf16 v[40:55], a[76:79], a[72:75], v[40:55]
  ds_read_b64_tr_b16 a[48:49], v11 offset:20480
  ds_read_b64_tr_b16 a[50:51], v11 offset:21504
  ds_read_b128 a[52:55], v13 offset:26624
  ds_read_b64_tr_b16 a[56:57], v11 offset:22528
  ds_read_b64_tr_b16 a[58:59], v11 offset:23552
  ds_read_b128 a[60:63], v13 offset:27648
  v_mfma_f32_32x32x16_bf16 v[40:55], a[84:87], a[80:83], v[40:55]
  v_mfma_f32_32x32x16_bf16 v[40:55], a[92:95], a[88:91], v[40:55]
  s_waitcnt lgkmcnt(12)
  s_barrier
  v_mfma_f32_32x32x16_bf16 v[40:55], a[4:7], a[0:3], v[40:55]
  ds_read_b64_tr_b16 a[64:65], v11 offset:32768
  ds_read_b64_tr_b16 a[66:67], v11 offset:33792
  ds_read_b128 a[68:71], v13 offset:40960
  ds_read_b64_tr_b16 a[72:73], v11 offset:34816
  ds_read_b64_tr_b16 a[74:75], v11 offset:35840
  ds_read_b128 a[76:79], v13 offset:41984
  v_mfma_f32_32x32x16_bf16 v[40:55], a[12:15], a[8:11], v[40:55]
  ds_read_b64_tr_b16 a[80:81], v11 offset:36864
  ds_read_b64_tr_b16 a[82:83], v11 offset:37888
  ds_read_b128 a[84:87], v13 offset:43008
  ds_read_b64_tr_b16 a[88:89], v11 offset:38912
  ds_read_b64_tr_b16 a[90:91], v11 offset:39936
  ds_read_b128 a[92:95], v13 offset:44032
  v_mfma_f32_32x32x16_bf16 v[40:55], a[20:23], a[16:19], v[40:55]
  v_mfma_f32_32x32x16_bf16 v[40:55], a[28:31], a[24:27], v[40:55]
  s_waitcnt lgkmcnt(12)
  s_barrier
  v_mfma_f32_32x32x16_bf16 v[40:55], a[36:39], a[32:35], v[40:55]
  ds_read_b64_tr_b16 a[0:1], v11 offset:49152
  ds_read_b64_tr_b16 a[2:3], v11 offset:50176
  ds_read_b128 a[4:7], v13 offset:57344
  ds_read_b64_tr_b16 a[8:9], v11 offset:51200
  ds_read_b64_tr_b16 a[10:11], v11 offset:52224
  ds_read_b128 a[12:15], v13 offset:58368
  v_mfma_f32_32x32x16_bf16 v[40:55], a[44:47], a[40:43], v[40:55]
  ds_read_b64_tr_b16 a[16:17], v11 offset:53248
  ds_read_b64_tr_b16 a[18:19], v11 offset:54272
  ds_read_b128 a[20:23], v13 offset:59392
  ds_read_b64_tr_b16 a[24:25], v11 offset:55296
  ds_read_b64_tr_b16 a[26:27], v11 offset:56320
  ds_read_b128 a[28:31], v13 offset:60416
  v_mfma_f32_32x32x16_bf16 v[40:55], a[52:55], a[48:51], v[40:55]
  v_mfma_f32_32x32x16_bf16 v[40:55], a[60:63], a[56:59], v[40:55]
  s_waitcnt lgkmcnt(12)
  s_barrier
  v_mfma_f32_32x32x16_bf16 v[40:55], a[68:71], a[64:67], v[40:55]
  ds_read_b64_tr_b16 a[32:33], v10 offset:0
  ds_read_b64_tr_b16 a[34:35], v10 offset:1024
  ds_read_b128 a[36:39], v12 offset:8192
  ds_read_b64_tr_b16 a[40:41], v10 offset:2048
  ds_read_b64_tr_b16 a[42:43], v10 offset:3072
  ds_read_b128 a[44:47], v12 offset:9216
  v_mfma_f32_32x32x16_bf16 v[40:55], a[76:79], a[72:75], v[40:55]
  ds_read_b64_tr_b16 a[48:49], v10 offset:4096
  ds_read_b64_tr_b16 a[50:51], v10 offset:5120
  ds_read_b128 a[52:55], v12 offset:10240
  ds_read_b64_tr_b16 a[56:57], v10 offset:6144
  ds_read_b64_tr_b16 a[58:59], v10 offset:7168
  ds_read_b128 a[60:63], v12 offset:11264
  v_mfma_f32_32x32x16_bf16 v[40:55], a[84:87], a[80:83], v[40:55]
  v_mfma_f32_32x32x16_bf16 v[40:55], a[92:95], a[88:91], v[40:55]
  s_waitcnt lgkmcnt(12)
  s_barrier
  v_mfma_f32_32x32x16_bf16 v[40:55], a[4:7], a[0:3], v[40:55]
  ds_read_b64_tr_b16 a[64:65], v10 offset:16384
  ds_read_b64_tr_b16 a[66:67], v10 offset:17408
  ds_read_b128 a[68:71], v12 offset:24576
  ds_read_b64_tr_b16 a[72:73], v10 offset:18432
  ds_read_b64_tr_b16 a[74:75], v10 offset:19456
  ds_read_b128 a[76:79], v12 offset:25600
  v_mfma_f32_32x32x16_bf16 v[40:55], a[12:15], a[8:11], v[40:55]
  ds_read_b64_tr_b16 a[80:81], v10 offset:20480
  ds_read_b64_tr_b16 a[82:83], v10 offset:21504
  ds_read_b128 a[84:87], v12 offset:26624
  ds_read_b64_tr_b16 a[88:89], v10 offset:22528
  ds_read_b64_tr_b16 a[90:91], v10 offset:23552
  ds_read_b128 a[92:95], v12 offset:27648
  v_mfma_f32_32x32x16_bf16 v[40:55], a[20:23], a[16:19], v[40:55]
  v_mfma_f32_32x32x16_bf16 v[40:55], a[28:31], a[24:27], v[40:55]
  s_waitcnt lgkmcnt(12)
  s_barrier
  v_mfma_f32_32x32x16_bf16 v[40:55], a[36:39], a[32:35], v[40:55]
  ds_read_b64_tr_b16 a[0:1], v10 offset:32768
  ds_read_b64_tr_b16 a[2:3], v10 offset:33792
  ds_read_b128 a[4:7], v12 offset:40960
  ds_read_b64_tr_b16 a[8:9], v10 offset:34816
  ds_read_b64_tr_b16 a[10:11], v10 offset:35840
  ds_read_b128 a[12:15], v12 offset:41984
  v_mfma_f32_32x32x16_bf16 v[40:55], a[44:47], a[40:43], v[40:55]
  ds_read_b64_tr_b16 a[16:17], v10 offset:36864
  ds_read_b64_tr_b16 a[18:19], v10 offset:37888
  ds_read_b128 a[20:23], v12 offset:43008
  ds_read_b64_tr_b16 a[24:25], v10 offset:38912
  ds_read_b64_tr_b16 a[26:27], v10 offset:39936
  ds_read_b128 a[28:31], v12 offset:44032
  v_mfma_f32_32x32x16_bf16 v[40:55], a[52:55], a[48:51], v[40:55]
  v_mfma_f32_32x32x16_bf16 v[40:55], a[60:63], a[56:59], v[40:55]
  s_waitcnt lgkmcnt(12)
  v_mfma_f32_32x32x16_bf16 v[40:55], a[68:71], a[64:67], v[40:55]
  v_mfma_f32_32x32x16_bf16 v[40:55], a[76:79], a[72:75], v[40:55]
  v_mfma_f32_32x32x16_bf16 v[40:55], a[84:87], a[80:83], v[40:55]
  v_mfma_f32_32x32x16_bf16 v[40:55], a[92:95], a[88:91], v[40:55]
  s_waitcnt lgkmcnt(0)
  s_barrier
  v_mfma_f32_32x32x16_bf16 v[40:55], a[4:7], a[0:3], v[40:55]
  v_mfma_f32_32x32x16_bf16 v[40:55], a[12:15], a[8:11], v[40:55]
  v_mfma_f32_32x32x16_bf16 v[40:55], a[20:23], a[16:19], v[40:55]
  v_mfma_f32_32x32x16_bf16 v[40:55], a[28:31], a[24:27], v[40:55]
  s_and_b32 s6, s79, 1
  s_lshl_b32 s6, s6, 6
  v_bfe_u32 v5, v1, 2, 2
  v_lshl_add_u32 v6, v3, 2, v5
  v_lshlrev_b32 v6, 7, v6
  v_lshrrev_b32 v5, 1, v5
  v_lshlrev_b32 v5, 6, v5
  v_xor_b32 v5, s6, v5
  v_add_u32 v6, v6, v5
  v_bfe_u32 v5, v1, 4, 1
  v_lshl_add_u32 v6, v5, 5, v6
  v_and_b32 v5, 3, v1
  v_lshl_add_u32 v10, v5, 3, v6
  v_add_u32 v11, 65536, v10
  s_lshr_b32 s4, s79, 1
  s_lshl_b32 s4, s4, 12
  v_lshlrev_b32 v5, 4, v1
  v_add_u32 v12, s4, v5
  v_add_u32 v13, 65536, v12
  v_add_u32 v112, 131072, v10
  v_add_u32 v113, 131072, v12
  s_barrier
  ds_read_b64_tr_b16 a[0:1], v112 offset:0
  ds_read_b64_tr_b16 a[2:3], v112 offset:1024
  ds_read_b128 a[4:7], v113 offset:8192
  ds_read_b64_tr_b16 a[8:9], v112 offset:2048
  ds_read_b64_tr_b16 a[10:11], v112 offset:3072
  ds_read_b128 a[12:15], v113 offset:9216
  ds_read_b64_tr_b16 a[16:17], v112 offset:4096
  ds_read_b64_tr_b16 a[18:19], v112 offset:5120
  ds_read_b128 a[20:23], v113 offset:10240
  ds_read_b64_tr_b16 a[24:25], v112 offset:6144
  ds_read_b64_tr_b16 a[26:27], v112 offset:7168
  ds_read_b128 a[28:31], v113 offset:11264
  s_barrier
  ds_read_b64_tr_b16 a[32:33], v10 offset:49152
  ds_read_b64_tr_b16 a[34:35], v10 offset:50176
  ds_read_b128 a[36:39], v12 offset:57344
  ds_read_b64_tr_b16 a[40:41], v10 offset:51200
  ds_read_b64_tr_b16 a[42:43], v10 offset:52224
  ds_read_b128 a[44:47], v12 offset:58368
  ds_read_b64_tr_b16 a[48:49], v10 offset:53248
  ds_read_b64_tr_b16 a[50:51], v10 offset:54272
  ds_read_b128 a[52:55], v12 offset:59392
  ds_read_b64_tr_b16 a[56:57], v10 offset:55296
  ds_read_b64_tr_b16 a[58:59], v10 offset:56320
  ds_read_b128 a[60:63], v12 offset:60416
  s_waitcnt lgkmcnt(12)
  s_barrier
  v_mfma_f32_32x32x16_bf16 v[56:71], a[0:3], a[4:7], 0
  ds_read_b64_tr_b16 a[64:65], v11 offset:0
  ds_read_b64_tr_b16 a[66:67], v11 offset:1024
  ds_read_b128 a[68:71], v13 offset:8192
  ds_read_b64_tr_b16 a[72:73], v11 offset:2048
  ds_read_b64_tr_b16 a[74:75], v11 offset:3072
  ds_read_b128 a[76:79], v13 offset:9216
  v_mfma_f32_32x32x16_bf16 v[56:71], a[8:11], a[12:15], v[56:71]
  ds_read_b64_tr_b16 a[80:81], v11 offset:4096
  ds_read_b64_tr_b16 a[82:83], v11 offset:5120
  ds_read_b128 a[84:87], v13 offset:10240
  ds_read_b64_tr_b16 a[88:89], v11 offset:6144
  ds_read_b64_tr_b16 a[90:91], v11 offset:7168
  ds_read_b128 a[92:95], v13 offset:11264
  v_mfma_f32_32x32x16_bf16 v[56:71], a[16:19], a[20:23], v[56:71]
  v_mfma_f32_32x32x16_bf16 v[56:71], a[24:27], a[28:31], v[56:71]
  s_waitcnt lgkmcnt(12)
  s_barrier
  v_mfma_f32_32x32x16_bf16 v[56:71], a[32:35], a[36:39], v[56:71]
  ds_read_b64_tr_b16 a[0:1], v11 offset:16384
  ds_read_b64_tr_b16 a[2:3], v11 offset:17408
  ds_read_b128 a[4:7], v13 offset:24576
  ds_read_b64_tr_b16 a[8:9], v11 offset:18432
  ds_read_b64_tr_b16 a[10:11], v11 offset:19456
  ds_read_b128 a[12:15], v13 offset:25600
  v_mfma_f32_32x32x16_bf16 v[56:71], a[40:43], a[44:47], v[56:71]
  ds_read_b64_tr_b16 a[16:17], v11 offset:20480
  ds_read_b64_tr_b16 a[18:19], v11 offset:21504
  ds_read_b128 a[20:23], v13 offset:26624
  ds_read_b64_tr_b16 a[24:25], v11 offset:22528
  ds_read_b64_tr_b16 a[26:27], v11 offset:23552
  ds_read_b128 a[28:31], v13 offset:27648
  v_mfma_f32_32x32x16_bf16 v[56:71], a[48:51], a[52:55], v[56:71]
  v_mfma_f32_32x32x16_bf16 v[56:71], a[56:59], a[60:63], v[56:71]
  s_waitcnt lgkmcnt(12)
  s_barrier
  v_mfma_f32_32x32x16_bf16 v[56:71], a[64:67], a[68:71], v[56:71]
  ds_read_b64_tr_b16 a[32:33], v11 offset:32768
  ds_read_b64_tr_b16 a[34:35], v11 offset:33792
  ds_read_b128 a[36:39], v13 offset:40960
  ds_read_b64_tr_b16 a[40:41], v11 offset:34816
  ds_read_b64_tr_b16 a[42:43], v11 offset:35840
  ds_read_b128 a[44:47], v13 offset:41984
  v_mfma_f32_32x32x16_bf16 v[56:71], a[72:75], a[76:79], v[56:71]
  ds_read_b64_tr_b16 a[48:49], v11 offset:36864
  ds_read_b64_tr_b16 a[50:51], v11 offset:37888
  ds_read_b128 a[52:55], v13 offset:43008
  ds_read_b64_tr_b16 a[56:57], v11 offset:38912
  ds_read_b64_tr_b16 a[58:59], v11 offset:39936
  ds_read_b128 a[60:63], v13 offset:44032
  v_mfma_f32_32x32x16_bf16 v[56:71], a[80:83], a[84:87], v[56:71]
  v_mfma_f32_32x32x16_bf16 v[56:71], a[88:91], a[92:95], v[56:71]
  s_waitcnt lgkmcnt(12)
  s_barrier
  v_mfma_f32_32x32x16_bf16 v[56:71], a[0:3], a[4:7], v[56:71]
  ds_read_b64_tr_b16 a[64:65], v11 offset:49152
  ds_read_b64_tr_b16 a[66:67], v11 offset:50176
  ds_read_b128 a[68:71], v13 offset:57344
  ds_read_b64_tr_b16 a[72:73], v11 offset:51200
  ds_read_b64_tr_b16 a[74:75], v11 offset:52224
  ds_read_b128 a[76:79], v13 offset:58368
  v_mfma_f32_32x32x16_bf16 v[56:71], a[8:11], a[12:15], v[56:71]
  ds_read_b64_tr_b16 a[80:81], v11 offset:53248
  ds_read_b64_tr_b16 a[82:83], v11 offset:54272
  ds_read_b128 a[84:87], v13 offset:59392
  ds_read_b64_tr_b16 a[88:89], v11 offset:55296
  ds_read_b64_tr_b16 a[90:91], v11 offset:56320
  ds_read_b128 a[92:95], v13 offset:60416
  v_mfma_f32_32x32x16_bf16 v[56:71], a[16:19], a[20:23], v[56:71]
  v_mfma_f32_32x32x16_bf16 v[56:71], a[24:27], a[28:31], v[56:71]
  s_waitcnt lgkmcnt(12)
  s_barrier
  v_mfma_f32_32x32x16_bf16 v[56:71], a[32:35], a[36:39], v[56:71]
  ds_read_b64_tr_b16 a[0:1], v10 offset:0
  ds_read_b64_tr_b16 a[2:3], v10 offset:1024
  ds_read_b128 a[4:7], v12 offset:8192
  ds_read_b64_tr_b16 a[8:9], v10 offset:2048
  ds_read_b64_tr_b16 a[10:11], v10 offset:3072
  ds_read_b128 a[12:15], v12 offset:9216
  v_mfma_f32_32x32x16_bf16 v[56:71], a[40:43], a[44:47], v[56:71]
  ds_read_b64_tr_b16 a[16:17], v10 offset:4096
  ds_read_b64_tr_b16 a[18:19], v10 offset:5120
  ds_read_b128 a[20:23], v12 offset:10240
  ds_read_b64_tr_b16 a[24:25], v10 offset:6144
  ds_read_b64_tr_b16 a[26:27], v10 offset:7168
  ds_read_b128 a[28:31], v12 offset:11264
  v_mfma_f32_32x32x16_bf16 v[56:71], a[48:51], a[52:55], v[56:71]
  v_mfma_f32_32x32x16_bf16 v[56:71], a[56:59], a[60:63], v[56:71]
  s_waitcnt lgkmcnt(12)
  s_barrier
  v_mfma_f32_32x32x16_bf16 v[56:71], a[64:67], a[68:71], v[56:71]
  ds_read_b64_tr_b16 a[32:33], v10 offset:16384
  ds_read_b64_tr_b16 a[34:35], v10 offset:17408
  ds_read_b128 a[36:39], v12 offset:24576
  ds_read_b64_tr_b16 a[40:41], v10 offset:18432
  ds_read_b64_tr_b16 a[42:43], v10 offset:19456
  ds_read_b128 a[44:47], v12 offset:25600
  v_mfma_f32_32x32x16_bf16 v[56:71], a[72:75], a[76:79], v[56:71]
  ds_read_b64_tr_b16 a[48:49], v10 offset:20480
  ds_read_b64_tr_b16 a[50:51], v10 offset:21504
  ds_read_b128 a[52:55], v12 offset:26624
  ds_read_b64_tr_b16 a[56:57], v10 offset:22528
  ds_read_b64_tr_b16 a[58:59], v10 offset:23552
  ds_read_b128 a[60:63], v12 offset:27648
  v_mfma_f32_32x32x16_bf16 v[56:71], a[80:83], a[84:87], v[56:71]
  v_mfma_f32_32x32x16_bf16 v[56:71], a[88:91], a[92:95], v[56:71]
  s_waitcnt lgkmcnt(12)
  v_mfma_f32_32x32x16_bf16 v[56:71], a[0:3], a[4:7], v[56:71]
  v_mfma_f32_32x32x16_bf16 v[56:71], a[8:11], a[12:15], v[56:71]
  v_mfma_f32_32x32x16_bf16 v[56:71], a[16:19], a[20:23], v[56:71]
  v_mfma_f32_32x32x16_bf16 v[56:71], a[24:27], a[28:31], v[56:71]
  s_waitcnt lgkmcnt(0)
  v_mfma_f32_32x32x16_bf16 v[56:71], a[32:35], a[36:39], v[56:71]
  v_mfma_f32_32x32x16_bf16 v[56:71], a[40:43], a[44:47], v[56:71]
  v_mfma_f32_32x32x16_bf16 v[56:71], a[48:51], a[52:55], v[56:71]
  v_mfma_f32_32x32x16_bf16 v[56:71], a[56:59], a[60:63], v[56:71]
  v_sub_f32 v88, 1.0, v14
  v_mov_b32 v90, v14
  v_pk_mul_f32 v[40:41], v[40:41], v[88:89] op_sel_hi:[1,0]
  v_pk_mul_f32 v[42:43], v[42:43], v[88:89] op_sel_hi:[1,0]
  v_pk_mul_f32 v[44:45], v[44:45], v[88:89] op_sel_hi:[1,0]
  v_pk_mul_f32 v[46:47], v[46:47], v[88:89] op_sel_hi:[1,0]
  v_pk_mul_f32 v[48:49], v[48:49], v[88:89] op_sel_hi:[1,0]
  v_pk_mul_f32 v[50:51], v[50:51], v[88:89] op_sel_hi:[1,0]
  v_pk_mul_f32 v[52:53], v[52:53], v[88:89] op_sel_hi:[1,0]
  v_pk_mul_f32 v[54:55], v[54:55], v[88:89] op_sel_hi:[1,0]
  s_nop 1
  v_pk_fma_f32 v[40:41], v[56:57], v[90:91], v[40:41] op_sel_hi:[1,0,1]
  v_pk_fma_f32 v[42:43], v[58:59], v[90:91], v[42:43] op_sel_hi:[1,0,1]
  v_pk_fma_f32 v[44:45], v[60:61], v[90:91], v[44:45] op_sel_hi:[1,0,1]
  v_pk_fma_f32 v[46:47], v[62:63], v[90:91], v[46:47] op_sel_hi:[1,0,1]
  v_pk_fma_f32 v[48:49], v[64:65], v[90:91], v[48:49] op_sel_hi:[1,0,1]
  v_pk_fma_f32 v[50:51], v[66:67], v[90:91], v[50:51] op_sel_hi:[1,0,1]
  v_pk_fma_f32 v[52:53], v[68:69], v[90:91], v[52:53] op_sel_hi:[1,0,1]
  v_pk_fma_f32 v[54:55], v[70:71], v[90:91], v[54:55] op_sel_hi:[1,0,1]
  v_cvt_pk_bf16_f32 v24, v40, v41
  v_cvt_pk_bf16_f32 v25, v42, v43
  v_cvt_pk_bf16_f32 v26, v44, v45
  v_cvt_pk_bf16_f32 v27, v46, v47
  v_cvt_pk_bf16_f32 v28, v48, v49
  v_cvt_pk_bf16_f32 v29, v50, v51
  v_cvt_pk_bf16_f32 v30, v52, v53
  v_cvt_pk_bf16_f32 v31, v54, v55
  v_permlane32_swap_b32 v24, v26
  v_permlane32_swap_b32 v25, v27
  v_permlane32_swap_b32 v28, v30
  v_permlane32_swap_b32 v29, v31
  s_lshl_b32 s4, s89, 6
  s_lshr_b32 s5, s79, 1
  s_lshl_b32 s5, s5, 5
  s_add_u32 s4, s4, s5
  v_add_u32 v5, s4, v2
  v_lshlrev_b32 v5, 10, v5
  v_lshl_add_u32 v5, v3, 4, v5
  s_lshl_b32 s4, s90, 7
  s_and_b32 s5, s79, 1
  s_lshl_b32 s5, s5, 6
  s_add_u32 s4, s4, s5
  buffer_store_dwordx4 v[24:27], v5, s[32:35], s4 offen
  buffer_store_dwordx4 v[28:31], v5, s[32:35], s4 offen offset:32
  s_endpgm
L_loader_cut:
  s_lshr_b32 s4, s80, 1
  s_and_b32 s5, s4, 1
  s_sub_u32 s7, 6, s5
  s_lshl_b32 s7, s7, 2
  s_mul_i32 s5, s4, 11
  s_add_u32 s5, s5, 1
  s_lshr_b32 s5, s5, 1
  s_lshr_b32 s6, s81, 2
  s_add_u32 s87, s5, s6
  s_and_b32 s5, s80, 1
  s_lshl_b32 s5, s5, 2
  s_and_b32 s6, s81, 3
  s_xor_b32 s6, s6, 0
  s_add_u32 s86, s5, s6
  s_mov_b32 s85, 0
  s_and_b32 s4, s80, 3
  s_lshl_b32 s89, s4, 3
  s_lshr_b32 s4, s81, 2
  s_add_u32 s89, s89, s4
  s_lshr_b32 s4, s80, 2
  s_lshl_b32 s90, s4, 2
  s_and_b32 s4, s81, 3
  s_add_u32 s90, s90, s4
  s_cmp_lt_u32 s81, s7
  s_cbranch_scc1 L_role_22
  s_sub_u32 s4, s81, s7
  s_mov_b32 s85, 2
  s_cmp_eq_u32 s7, 24
  s_cselect_b32 s5, 4, 12
  s_cmp_ge_u32 s4, s5
  s_cbranch_scc1 L_role_22
  s_mov_b32 s85, 1
  s_and_b32 s5, s80, 1
  s_lshr_b32 s6, s80, 2
  s_lshl_b32 s6, s6, 1
  s_add_u32 s5, s5, s6
  s_mul_i32 s6, s5, 3
  s_lshr_b32 s86, s4, 2
  s_add_u32 s6, s6, s86
  s_add_u32 s5, s5, 12
  s_cmp_eq_u32 s7, 24
  s_cselect_b32 s86, s5, s6
  s_and_b32 s87, s4, 3
L_role_22:
  s_barrier
  s_waitcnt vmcnt(10)
  s_add_u32 m0, s88, 106496
  s_nop 0
  buffer_load_dwordx4 v17, s[12:15], s65 offen  lds
  s_waitcnt vmcnt(10)
  s_add_u32 m0, s88, 107520
  s_nop 0
  buffer_load_dwordx4 v18, s[12:15], s65 offen  lds
  s_waitcnt vmcnt(10)
  s_add_u32 m0, s88, 114688
  s_nop 0
  buffer_load_dwordx4 v17, s[12:15], s66 offen  lds
  s_waitcnt vmcnt(10)
  s_add_u32 m0, s88, 115712
  s_nop 0
  buffer_load_dwordx4 v18, s[12:15], s66 offen  lds
  s_waitcnt vmcnt(10)
  s_add_u32 m0, s88, 98304
  s_nop 0
  buffer_load_dwordx4 v15, s[8:11], s64 offen  lds
  s_waitcnt vmcnt(10)
  s_add_u32 m0, s88, 99328
  s_nop 0
  buffer_load_dwordx4 v16, s[8:11], s64 offen  lds
  s_add_u32 s64, s64, 128
  s_cmp_eq_u32 s64, 1024
  s_cselect_b32 s64, 0, s64
  s_add_u32 s65, s65, 196608
  s_cmp_eq_u32 s65, 1572864
  s_cselect_b32 s65, 0, s65
  s_add_u32 s66, s65, 1024
  s_barrier
  s_waitcnt vmcnt(10)
  s_add_u32 m0, s88, 8192
  s_nop 0
  buffer_load_dwordx4 v17, s[12:15], s65 offen  lds
  s_waitcnt vmcnt(10)
  s_add_u32 m0, s88, 9216
  s_nop 0
  buffer_load_dwordx4 v18, s[12:15], s65 offen  lds
  s_waitcnt vmcnt(10)
  s_add_u32 m0, s88, 16384
  s_nop 0
  buffer_load_dwordx4 v17, s[12:15], s66 offen  lds
  s_waitcnt vmcnt(10)
  s_add_u32 m0, s88, 17408
  s_nop 0
  buffer_load_dwordx4 v18, s[12:15], s66 offen  lds
  s_waitcnt vmcnt(10)
  s_add_u32 m0, s88, 0
  s_nop 0
  buffer_load_dwordx4 v15, s[8:11], s64 offen  lds
  s_waitcnt vmcnt(10)
  s_add_u32 m0, s88, 1024
  s_nop 0
  buffer_load_dwordx4 v16, s[8:11], s64 offen  lds
  s_add_u32 s64, s64, 128
  s_cmp_eq_u32 s64, 1024
  s_cselect_b32 s64, 0, s64
  s_add_u32 s65, s65, 196608
  s_cmp_eq_u32 s65, 1572864
  s_cselect_b32 s65, 0, s65
  s_add_u32 s66, s65, 1024
  s_barrier
  s_waitcnt vmcnt(10)
  s_add_u32 m0, s88, 32768
  s_nop 0
  buffer_load_dwordx4 v17, s[12:15], s65 offen  lds
  s_waitcnt vmcnt(10)
  s_add_u32 m0, s88, 33792
  s_nop 0
  buffer_load_dwordx4 v18, s[12:15], s65 offen  lds
  s_waitcnt vmcnt(10)
  s_add_u32 m0, s88, 40960
  s_nop 0
  buffer_load_dwordx4 v17, s[12:15], s66 offen  lds
  s_waitcnt vmcnt(10)
  s_add_u32 m0, s88, 41984
  s_nop 0
  buffer_load_dwordx4 v18, s[12:15], s66 offen  lds
  s_waitcnt vmcnt(10)
  s_add_u32 m0, s88, 24576
  s_nop 0
  buffer_load_dwordx4 v15, s[8:11], s64 offen  lds
  s_waitcnt vmcnt(10)
  s_add_u32 m0, s88, 25600
  s_nop 0
  buffer_load_dwordx4 v16, s[8:11], s64 offen  lds
  s_add_u32 s64, s64, 128
  s_cmp_eq_u32 s64, 1024
  s_cselect_b32 s64, 0, s64
  s_add_u32 s65, s65, 196608
  s_cmp_eq_u32 s65, 1572864
  s_cselect_b32 s65, 0, s65
  s_add_u32 s66, s65, 1024
  s_barrier
  s_waitcnt vmcnt(10)
  s_add_u32 m0, s88, 57344
  s_nop 0
  buffer_load_dwordx4 v17, s[12:15], s65 offen  lds
  s_waitcnt vmcnt(10)
  s_add_u32 m0, s88, 58368
  s_nop 0
  buffer_load_dwordx4 v18, s[12:15], s65 offen  lds
  s_waitcnt vmcnt(10)
  s_add_u32 m0, s88, 65536
  s_nop 0
  buffer_load_dwordx4 v17, s[12:15], s66 offen  lds
  s_waitcnt vmcnt(10)
  s_add_u32 m0, s88, 66560
  s_nop 0
  buffer_load_dwordx4 v18, s[12:15], s66 offen  lds
  s_waitcnt vmcnt(10)
  s_add_u32 m0, s88, 49152
  s_nop 0
  buffer_load_dwordx4 v15, s[8:11], s64 offen  lds
  s_waitcnt vmcnt(10)
  s_add_u32 m0, s88, 50176
  s_nop 0
  buffer_load_dwordx4 v16, s[8:11], s64 offen  lds
  s_add_u32 s64, s64, 128
  s_cmp_eq_u32 s64, 1024
  s_cselect_b32 s64, 0, s64
  s_add_u32 s65, s65, 196608
  s_cmp_eq_u32 s65, 1572864
  s_cselect_b32 s65, 0, s65
  s_add_u32 s66, s65, 1024
  s_cmp_eq_u32 s85, 1
  s_cbranch_scc1 L_l_q
  s_cmp_eq_u32 s85, 2
  s_cbranch_scc1 L_l_i
  s_branch L_l_b1
L_l_q:
  s_lshl_b32 s6, s86, 17
  s_lshl_b32 s4, s79, 4
  v_add_u32 v5, s4, v11
  v_lshlrev_b32 v5, 10, v5
  v_add_u32 v5, s6, v5
  v_and_b32 v6, 7, v1
  v_lshrrev_b32 v7, 4, v1
  v_xor_b32 v6, v6, v7
  v_lshl_add_u32 v33, v6, 4, v5
  v_xor_b32 v6, 4, v6
  v_lshl_add_u32 v34, v6, 4, v5
  v_add_u32 v34, 8192, v34
  s_lshl_b32 s6, s87, 8
  s_lshl_b32 s4, s79, 4
  v_add_u32 v5, s4, v11
  s_mov_b32 s5, 3072
  v_mul_lo_u32 v5, v5, s5
  v_add_u32 v5, v5, v10
  v_add_u32 v35, s6, v5
  v_add_u32 v36, 24576, v35
  s_and_b32 s4, s87, 3
  s_lshl_b32 s4, s4, 1
  s_and_b32 s5, s86, 1
  s_add_u32 s4, s4, s5
  s_add_u32 s4, s4, s80
  s_and_b32 s4, s4, 7
  s_lshl_b32 s73, s4, 7
  s_add_u32 s95, s73, 65536
  s_mul_i32 s96, s4, 196608
  s_add_u32 s97, s96, 128
  s_barrier
  s_barrier
  s_waitcnt vmcnt(6)
  s_barrier
  s_waitcnt vmcnt(0)
  s_barrier
  s_barrier
  s_add_u32 m0, s88, 106496
  s_nop 0
  buffer_load_dwordx4 v35, s[12:15], s96 offen  lds
  s_add_u32 m0, s88, 107520
  s_nop 0
  buffer_load_dwordx4 v36, s[12:15], s96 offen  lds
  s_add_u32 m0, s88, 98304
  s_nop 0
  buffer_load_dwordx4 v33, s[8:11], s73 offen  lds
  s_add_u32 m0, s88, 99328
  s_nop 0
  buffer_load_dwordx4 v34, s[8:11], s73 offen  lds
  s_add_u32 m0, s88, 122880
  s_nop 0
  buffer_load_dwordx4 v35, s[12:15], s97 offen  lds
  s_add_u32 m0, s88, 123904
  s_nop 0
  buffer_load_dwordx4 v36, s[12:15], s97 offen  lds
  s_add_u32 m0, s88, 114688
  s_nop 0
  buffer_load_dwordx4 v33, s[8:11], s95 offen  lds
  s_add_u32 m0, s88, 115712
  s_nop 0
  buffer_load_dwordx4 v34, s[8:11], s95 offen  lds
  s_add_u32 s73, s73, 128
  s_cmp_eq_u32 s73, 1024
  s_cselect_b32 s73, 0, s73
  s_add_u32 s95, s73, 65536
  s_add_u32 s96, s96, 196608
  s_cmp_eq_u32 s96, 1572864
  s_cselect_b32 s96, 0, s96
  s_add_u32 s97, s96, 128
  s_add_u32 m0, s88, 8192
  s_nop 0
  buffer_load_dwordx4 v35, s[12:15], s96 offen  lds
  s_add_u32 m0, s88, 9216
  s_nop 0
  buffer_load_dwordx4 v36, s[12:15], s96 offen  lds
  s_add_u32 m0, s88, 0
  s_nop 0
  buffer_load_dwordx4 v33, s[8:11], s73 offen  lds
  s_waitcnt vmcnt(10)
  s_add_u32 m0, s88, 1024
  s_nop 0
  buffer_load_dwordx4 v34, s[8:11], s73 offen  lds
  s_waitcnt vmcnt(10)
  s_add_u32 m0, s88, 24576
  s_nop 0
  buffer_load_dwordx4 v35, s[12:15], s97 offen  lds
  s_waitcnt vmcnt(10)
  s_add_u32 m0, s88, 25600
  s_nop 0
  buffer_load_dwordx4 v36, s[12:15], s97 offen  lds
  s_waitcnt vmcnt(10)
  s_add_u32 m0, s88, 16384
  s_nop 0
  buffer_load_dwordx4 v33, s[8:11], s95 offen  lds
  s_waitcnt vmcnt(10)
  s_add_u32 m0, s88, 17408
  s_nop 0
  buffer_load_dwordx4 v34, s[8:11], s95 offen  lds
  s_add_u32 s73, s73, 128
  s_cmp_eq_u32 s73, 1024
  s_cselect_b32 s73, 0, s73
  s_add_u32 s95, s73, 65536
  s_add_u32 s96, s96, 196608
  s_cmp_eq_u32 s96, 1572864
  s_cselect_b32 s96, 0, s96
  s_add_u32 s97, s96, 128
  s_waitcnt vmcnt(10)
  s_add_u32 m0, s88, 40960
  s_nop 0
  buffer_load_dwordx4 v35, s[12:15], s96 offen  lds
  s_waitcnt vmcnt(10)
  s_add_u32 m0, s88, 41984
  s_nop 0
  buffer_load_dwordx4 v36, s[12:15], s96 offen  lds
  s_waitcnt vmcnt(10)
  s_add_u32 m0, s88, 32768
  s_nop 0
  buffer_load_dwordx4 v33, s[8:11], s73 offen  lds
  s_waitcnt vmcnt(10)
  s_add_u32 m0, s88, 33792
  s_nop 0
  buffer_load_dwordx4 v34, s[8:11], s73 offen  lds
  s_waitcnt vmcnt(10)
  s_add_u32 m0, s88, 57344
  s_nop 0
  buffer_load_dwordx4 v35, s[12:15], s97 offen  lds
  s_waitcnt vmcnt(10)
  s_add_u32 m0, s88, 58368
  s_nop 0
  buffer_load_dwordx4 v36, s[12:15], s97 offen  lds
  s_waitcnt vmcnt(10)
  s_add_u32 m0, s88, 49152
  s_nop 0
  buffer_load_dwordx4 v33, s[8:11], s95 offen  lds
  s_waitcnt vmcnt(10)
  s_add_u32 m0, s88, 50176
  s_nop 0
  buffer_load_dwordx4 v34, s[8:11], s95 offen  lds
  s_add_u32 s73, s73, 128
  s_cmp_eq_u32 s73, 1024
  s_cselect_b32 s73, 0, s73
  s_add_u32 s95, s73, 65536
  s_add_u32 s96, s96, 196608
  s_cmp_eq_u32 s96, 1572864
  s_cselect_b32 s96, 0, s96
  s_add_u32 s97, s96, 128
  s_cmp_lg_u32 s79, 0
  s_cbranch_scc1 L_pb_36
  v_and_b32 v13, 7, v1
  v_lshlrev_b32 v13, 5, v13
  global_load_dword v12, v13, s[74:75] sc1
L_pb_36:
  s_waitcnt vmcnt(10)
  s_add_u32 m0, s88, 73728
  s_nop 0
  buffer_load_dwordx4 v35, s[12:15], s96 offen  lds
  s_waitcnt vmcnt(10)
  s_add_u32 m0, s88, 74752
  s_nop 0
  buffer_load_dwordx4 v36, s[12:15], s96 offen  lds
  s_waitcnt vmcnt(10)
  s_add_u32 m0, s88, 65536
  s_nop 0
  buffer_load_dwordx4 v33, s[8:11], s73 offen  lds
  s_waitcnt vmcnt(10)
  s_add_u32 m0, s88, 66560
  s_nop 0
  buffer_load_dwordx4 v34, s[8:11], s73 offen  lds
  s_waitcnt vmcnt(10)
  s_add_u32 m0, s88, 90112
  s_nop 0
  buffer_load_dwordx4 v35, s[12:15], s97 offen  lds
  s_waitcnt vmcnt(10)
  s_add_u32 m0, s88, 91136
  s_nop 0
  buffer_load_dwordx4 v36, s[12:15], s97 offen  lds
  s_waitcnt vmcnt(10)
  s_add_u32 m0, s88, 81920
  s_nop 0
  buffer_load_dwordx4 v33, s[8:11], s95 offen  lds
  s_waitcnt vmcnt(10)
  s_add_u32 m0, s88, 82944
  s_nop 0
  buffer_load_dwordx4 v34, s[8:11], s95 offen  lds
  s_add_u32 s73, s73, 128
  s_cmp_eq_u32 s73, 1024
  s_cselect_b32 s73, 0, s73
  s_add_u32 s95, s73, 65536
  s_add_u32 s96, s96, 196608
  s_cmp_eq_u32 s96, 1572864
  s_cselect_b32 s96, 0, s96
  s_add_u32 s97, s96, 128
  s_cmp_lg_u32 s79, 0
  s_cbranch_scc1 L_gp_37
  s_mov_b32 s7, 131072
  s_waitcnt vmcnt(8)
  v_cmp_gt_u32 vcc, 32, v12
  s_cbranch_vccz L_go_39
L_gs_38:
  global_load_dword v12, v13, s[74:75] sc1
  s_waitcnt vmcnt(0)
  v_cmp_gt_u32 vcc, 32, v12
  s_cbranch_vccz L_go_39
  s_sub_u32 s7, s7, 1
  s_cmp_eq_u32 s7, 0
  s_cbranch_scc1 L_go_39
  s_sleep 1
  s_branch L_gs_38
L_go_39:
  v_mov_b32 v5, 162836
  v_mov_b32 v6, 1
  ds_write_b32 v5, v6
  s_branch L_gf_40
L_gp_37:
  v_mov_b32 v5, 162836
  s_mov_b32 s7, 1048576
L_ls_41:
  ds_read_b32 v6, v5
  s_waitcnt lgkmcnt(0)
  v_readfirstlane_b32 s4, v6
  s_nop 3
  s_cmp_ge_u32 s4, 1
  s_cbranch_scc1 L_lo_42
  s_sub_u32 s7, s7, 1
  s_cmp_eq_u32 s7, 0
  s_cbranch_scc1 L_lo_42
  s_sleep 1
  s_branch L_ls_41
L_lo_42:
L_gf_40:
  s_barrier
  s_barrier
  s_waitcnt vmcnt(10)
  s_add_u32 m0, s88, 106496
  s_nop 0
  buffer_load_dwordx4 v35, s[12:15], s96 offen  lds
  s_waitcnt vmcnt(10)
  s_add_u32 m0, s88, 107520
  s_nop 0
  buffer_load_dwordx4 v36, s[12:15], s96 offen  lds
  s_waitcnt vmcnt(10)
  s_add_u32 m0, s88, 98304
  s_nop 0
  buffer_load_dwordx4 v33, s[8:11], s73 offen  lds
  s_waitcnt vmcnt(10)
  s_add_u32 m0, s88, 99328
  s_nop 0
  buffer_load_dwordx4 v34, s[8:11], s73 offen  lds
  s_waitcnt vmcnt(10)
  s_add_u32 m0, s88, 122880
  s_nop 0
  buffer_load_dwordx4 v35, s[12:15], s97 offen  lds
  s_waitcnt vmcnt(10)
  s_add_u32 m0, s88, 123904
  s_nop 0
  buffer_load_dwordx4 v36, s[12:15], s97 offen  lds
  s_waitcnt vmcnt(10)
  s_add_u32 m0, s88, 114688
  s_nop 0
  buffer_load_dwordx4 v33, s[8:11], s95 offen  lds
  s_waitcnt vmcnt(10)
  s_add_u32 m0, s88, 115712
  s_nop 0
  buffer_load_dwordx4 v34, s[8:11], s95 offen  lds
  s_add_u32 s73, s73, 128
  s_cmp_eq_u32 s73, 1024
  s_cselect_b32 s73, 0, s73
  s_add_u32 s95, s73, 65536
  s_add_u32 s96, s96, 196608
  s_cmp_eq_u32 s96, 1572864
  s_cselect_b32 s96, 0, s96
  s_add_u32 s97, s96, 128
  s_barrier
  s_waitcnt vmcnt(10)
  s_add_u32 m0, s88, 8192
  s_nop 0
  buffer_load_dwordx4 v35, s[12:15], s96 offen  lds
  s_waitcnt vmcnt(10)
  s_add_u32 m0, s88, 9216
  s_nop 0
  buffer_load_dwordx4 v36, s[12:15], s96 offen  lds
  s_waitcnt vmcnt(10)
  s_add_u32 m0, s88, 0
  s_nop 0
  buffer_load_dwordx4 v33, s[8:11], s73 offen  lds
  s_waitcnt vmcnt(10)
  s_add_u32 m0, s88, 1024
  s_nop 0
  buffer_load_dwordx4 v34, s[8:11], s73 offen  lds
  s_waitcnt vmcnt(10)
  s_add_u32 m0, s88, 24576
  s_nop 0
  buffer_load_dwordx4 v35, s[12:15], s97 offen  lds
  s_waitcnt vmcnt(10)
  s_add_u32 m0, s88, 25600
  s_nop 0
  buffer_load_dwordx4 v36, s[12:15], s97 offen  lds
  s_waitcnt vmcnt(10)
  s_add_u32 m0, s88, 16384
  s_nop 0
  buffer_load_dwordx4 v33, s[8:11], s95 offen  lds
  s_waitcnt vmcnt(10)
  s_add_u32 m0, s88, 17408
  s_nop 0
  buffer_load_dwordx4 v34, s[8:11], s95 offen  lds
  s_add_u32 s73, s73, 128
  s_cmp_eq_u32 s73, 1024
  s_cselect_b32 s73, 0, s73
  s_add_u32 s95, s73, 65536
  s_add_u32 s96, s96, 196608
  s_cmp_eq_u32 s96, 1572864
  s_cselect_b32 s96, 0, s96
  s_add_u32 s97, s96, 128
  s_barrier
  s_waitcnt vmcnt(10)
  s_add_u32 m0, s88, 40960
  s_nop 0
  buffer_load_dwordx4 v35, s[12:15], s96 offen  lds
  s_waitcnt vmcnt(10)
  s_add_u32 m0, s88, 41984
  s_nop 0
  buffer_load_dwordx4 v36, s[12:15], s96 offen  lds
  s_waitcnt vmcnt(10)
  s_add_u32 m0, s88, 32768
  s_nop 0
  buffer_load_dwordx4 v33, s[8:11], s73 offen  lds
  s_waitcnt vmcnt(10)
  s_add_u32 m0, s88, 33792
  s_nop 0
  buffer_load_dwordx4 v34, s[8:11], s73 offen  lds
  s_waitcnt vmcnt(10)
  s_add_u32 m0, s88, 57344
  s_nop 0
  buffer_load_dwordx4 v35, s[12:15], s97 offen  lds
  s_waitcnt vmcnt(10)
  s_add_u32 m0, s88, 58368
  s_nop 0
  buffer_load_dwordx4 v36, s[12:15], s97 offen  lds
  s_waitcnt vmcnt(10)
  s_add_u32 m0, s88, 49152
  s_nop 0
  buffer_load_dwordx4 v33, s[8:11], s95 offen  lds
  s_waitcnt vmcnt(10)
  s_add_u32 m0, s88, 50176
  s_nop 0
  buffer_load_dwordx4 v34, s[8:11], s95 offen  lds
  s_add_u32 s73, s73, 128
  s_cmp_eq_u32 s73, 1024
  s_cselect_b32 s73, 0, s73
  s_add_u32 s95, s73, 65536
  s_add_u32 s96, s96, 196608
  s_cmp_eq_u32 s96, 1572864
  s_cselect_b32 s96, 0, s96
  s_add_u32 s97, s96, 128
  s_barrier
  s_waitcnt vmcnt(10)
  s_add_u32 m0, s88, 73728
  s_nop 0
  buffer_load_dwordx4 v35, s[12:15], s96 offen  lds
  s_waitcnt vmcnt(10)
  s_add_u32 m0, s88, 74752
  s_nop 0
  buffer_load_dwordx4 v36, s[12:15], s96 offen  lds
  s_waitcnt vmcnt(10)
  s_add_u32 m0, s88, 65536
  s_nop 0
  buffer_load_dwordx4 v33, s[8:11], s73 offen  lds
  s_waitcnt vmcnt(10)
  s_add_u32 m0, s88, 66560
  s_nop 0
  buffer_load_dwordx4 v34, s[8:11], s73 offen  lds
  s_waitcnt vmcnt(10)
  s_add_u32 m0, s88, 90112
  s_nop 0
  buffer_load_dwordx4 v35, s[12:15], s97 offen  lds
  s_waitcnt vmcnt(10)
  s_add_u32 m0, s88, 91136
  s_nop 0
  buffer_load_dwordx4 v36, s[12:15], s97 offen  lds
  s_waitcnt vmcnt(10)
  s_add_u32 m0, s88, 81920
  s_nop 0
  buffer_load_dwordx4 v33, s[8:11], s95 offen  lds
  s_waitcnt vmcnt(10)
  s_add_u32 m0, s88, 82944
  s_nop 0
  buffer_load_dwordx4 v34, s[8:11], s95 offen  lds
  s_add_u32 s73, s73, 128
  s_cmp_eq_u32 s73, 1024
  s_cselect_b32 s73, 0, s73
  s_add_u32 s95, s73, 65536
  s_add_u32 s96, s96, 196608
  s_cmp_eq_u32 s96, 1572864
  s_cselect_b32 s96, 0, s96
  s_add_u32 s97, s96, 128
  s_barrier
  s_waitcnt vmcnt(8)
  s_barrier
  s_waitcnt vmcnt(0)
  s_barrier
  s_cmp_lg_u32 s79, 0
  s_cbranch_scc1 L_pb_43
  s_lshl_b32 s4, s87, 12
  s_add_u32 s4, s4, 6488064
  v_lshlrev_b32 v13, 6, v1
  v_add_u32 v13, s4, v13
  buffer_load_dword v12, v13, s[28:31], 0 offen sc1
L_pb_43:
  s_barrier
  s_cmp_lg_u32 s79, 0
  s_cbranch_scc1 L_gp_44
  s_mov_b32 s7, 131072
  s_waitcnt vmcnt(0)
  v_cmp_gt_u32 vcc, 1, v12
  s_cbranch_vccz L_go_46
L_gs_45:
  buffer_load_dword v12, v13, s[28:31], 0 offen sc1
  s_waitcnt vmcnt(0)
  v_cmp_gt_u32 vcc, 1, v12
  s_cbranch_vccz L_go_46
  s_sub_u32 s7, s7, 1
  s_cmp_eq_u32 s7, 0
  s_cbranch_scc1 L_go_46
  s_sleep 1
  s_branch L_gs_45
L_go_46:
  v_mov_b32 v5, 162840
  v_mov_b32 v6, 1
  ds_write_b32 v5, v6
  s_branch L_gf_47
L_gp_44:
  v_mov_b32 v5, 162840
  s_mov_b32 s7, 1048576
L_ls_48:
  ds_read_b32 v6, v5
  s_waitcnt lgkmcnt(0)
  v_readfirstlane_b32 s4, v6
  s_nop 3
  s_cmp_ge_u32 s4, 1
  s_cbranch_scc1 L_lo_49
  s_sub_u32 s7, s7, 1
  s_cmp_eq_u32 s7, 0
  s_cbranch_scc1 L_lo_49
  s_sleep 1
  s_branch L_ls_48
L_lo_49:
L_gf_47:
  s_lshl_b32 s6, s89, 7
  s_lshl_b32 s4, s79, 4
  v_add_u32 v5, s4, v11
  s_mov_b32 s5, 4096
  v_mul_lo_u32 v5, v5, s5
  v_add_u32 v5, v5, v10
  v_add_u32 v30, s6, v5
  v_add_u32 v31, 32768, v30
  s_lshr_b32 s4, s81, 2
  s_mul_i32 s4, s4, 11
  s_lshr_b32 s4, s4, 2
  s_and_b32 s5, s81, 3
  s_mul_i32 s5, s5, 11
  s_lshr_b32 s5, s5, 1
  s_add_u32 s4, s4, s5
  s_sub_u32 s5, s4, 22
  s_cmp_ge_u32 s4, 22
  s_cselect_b32 s4, s5, s4
  s_sub_u32 s5, s4, 22
  s_cmp_ge_u32 s4, 22
  s_cselect_b32 s71, s5, s4
  s_lshl_b32 s72, s71, 18
  s_add_u32 m0, s88, 81920
  s_nop 0
  buffer_load_dwordx4 v30, s[24:27], s72 offen  lds
  s_add_u32 m0, s88, 82944
  s_nop 0
  buffer_load_dwordx4 v31, s[24:27], s72 offen  lds
  s_add_u32 s72, s72, 262144
  s_cmp_eq_u32 s72, 5767168
  s_cselect_b32 s72, 0, s72
  s_add_u32 m0, s88, 98304
  s_nop 0
  buffer_load_dwordx4 v30, s[24:27], s72 offen  lds
  s_add_u32 m0, s88, 99328
  s_nop 0
  buffer_load_dwordx4 v31, s[24:27], s72 offen  lds
  s_add_u32 s72, s72, 262144
  s_cmp_eq_u32 s72, 5767168
  s_cselect_b32 s72, 0, s72
  s_add_u32 m0, s88, 114688
  s_nop 0
  buffer_load_dwordx4 v30, s[24:27], s72 offen  lds
  s_add_u32 m0, s88, 115712
  s_nop 0
  buffer_load_dwordx4 v31, s[24:27], s72 offen  lds
  s_add_u32 s72, s72, 262144
  s_cmp_eq_u32 s72, 5767168
  s_cselect_b32 s72, 0, s72
  s_add_u32 m0, s88, 0
  s_nop 0
  buffer_load_dwordx4 v30, s[24:27], s72 offen  lds
  s_add_u32 m0, s88, 1024
  s_nop 0
  buffer_load_dwordx4 v31, s[24:27], s72 offen  lds
  s_add_u32 s72, s72, 262144
  s_cmp_eq_u32 s72, 5767168
  s_cselect_b32 s72, 0, s72
  s_add_u32 m0, s88, 16384
  s_nop 0
  buffer_load_dwordx4 v30, s[24:27], s72 offen  lds
  s_add_u32 m0, s88, 17408
  s_nop 0
  buffer_load_dwordx4 v31, s[24:27], s72 offen  lds
  s_add_u32 s72, s72, 262144
  s_cmp_eq_u32 s72, 5767168
  s_cselect_b32 s72, 0, s72
  s_add_u32 m0, s88, 32768
  s_nop 0
  buffer_load_dwordx4 v30, s[24:27], s72 offen  lds
  s_waitcnt vmcnt(10)
  s_add_u32 m0, s88, 33792
  s_nop 0
  buffer_load_dwordx4 v31, s[24:27], s72 offen  lds
  s_add_u32 s72, s72, 262144
  s_cmp_eq_u32 s72, 5767168
  s_cselect_b32 s72, 0, s72
  s_waitcnt vmcnt(10)
  s_add_u32 m0, s88, 49152
  s_nop 0
  buffer_load_dwordx4 v30, s[24:27], s72 offen  lds
  s_waitcnt vmcnt(10)
  s_add_u32 m0, s88, 50176
  s_nop 0
  buffer_load_dwordx4 v31, s[24:27], s72 offen  lds
  s_add_u32 s72, s72, 262144
  s_cmp_eq_u32 s72, 5767168
  s_cselect_b32 s72, 0, s72
  s_waitcnt vmcnt(10)
  s_add_u32 m0, s88, 65536
  s_nop 0
  buffer_load_dwordx4 v30, s[24:27], s72 offen  lds
  s_waitcnt vmcnt(10)
  s_add_u32 m0, s88, 66560
  s_nop 0
  buffer_load_dwordx4 v31, s[24:27], s72 offen  lds
  s_add_u32 s72, s72, 262144
  s_cmp_eq_u32 s72, 5767168
  s_cselect_b32 s72, 0, s72
  s_cmp_lg_u32 s79, 0
  s_cbranch_scc1 L_gp_50
  s_mov_b32 s7, 131072
  v_min_u32 v13, 2, v1
  v_add_u32 v13, s71, v13
  v_subrev_u32 v5, 22, v13
  v_cmp_le_u32 vcc, 22, v13
  s_nop 1
  v_cndmask_b32 v13, v13, v5, vcc
  s_lshl_b32 s4, s90, 11
  s_add_u32 s4, s4, 6520832
  v_lshlrev_b32 v13, 6, v13
  v_add_u32 v13, s4, v13
L_gs_51:
  buffer_load_dword v12, v13, s[28:31], 0 offen sc1
  s_waitcnt vmcnt(0)
  v_cmp_gt_u32 vcc, 1, v12
  s_cbranch_vccz L_go_52
  s_sub_u32 s7, s7, 1
  s_cmp_eq_u32 s7, 0
  s_cbranch_scc1 L_go_52
  s_sleep 1
  s_branch L_gs_51
L_go_52:
  v_mov_b32 v5, 162848
  v_mov_b32 v6, 1
  ds_write_b32 v5, v6
  s_branch L_gf_53
L_gp_50:
  v_mov_b32 v5, 162848
  s_mov_b32 s7, 1048576
L_ls_54:
  ds_read_b32 v6, v5
  s_waitcnt lgkmcnt(0)
  v_readfirstlane_b32 s4, v6
  s_nop 3
  s_cmp_ge_u32 s4, 1
  s_cbranch_scc1 L_lo_55
  s_sub_u32 s7, s7, 1
  s_cmp_eq_u32 s7, 0
  s_cbranch_scc1 L_lo_55
  s_sleep 1
  s_branch L_ls_54
L_lo_55:
L_gf_53:
  s_branch L_l_merge
L_l_i:
  s_barrier
  s_barrier
  s_waitcnt vmcnt(6)
  s_barrier
  s_waitcnt vmcnt(0)
  s_barrier
  s_barrier
  s_cmp_lg_u32 s79, 0
  s_cbranch_scc1 L_gp_56
  s_mov_b32 s7, 131072
  v_and_b32 v13, 7, v1
  v_lshlrev_b32 v13, 5, v13
L_gs_57:
  global_load_dword v12, v13, s[74:75] sc1
  s_waitcnt vmcnt(0)
  v_cmp_gt_u32 vcc, 32, v12
  s_cbranch_vccz L_go_58
  s_sub_u32 s7, s7, 1
  s_cmp_eq_u32 s7, 0
  s_cbranch_scc1 L_go_58
  s_sleep 1
  s_branch L_gs_57
L_go_58:
  v_mov_b32 v5, 162836
  v_mov_b32 v6, 1
  ds_write_b32 v5, v6
  s_branch L_gf_59
L_gp_56:
  v_mov_b32 v5, 162836
  s_mov_b32 s7, 1048576
L_ls_60:
  ds_read_b32 v6, v5
  s_waitcnt lgkmcnt(0)
  v_readfirstlane_b32 s4, v6
  s_nop 3
  s_cmp_ge_u32 s4, 1
  s_cbranch_scc1 L_lo_61
  s_sub_u32 s7, s7, 1
  s_cmp_eq_u32 s7, 0
  s_cbranch_scc1 L_lo_61
  s_sleep 1
  s_branch L_ls_60
L_lo_61:
L_gf_59:
  s_lshl_b32 s6, s89, 7
  s_lshl_b32 s4, s79, 4
  v_add_u32 v5, s4, v11
  s_mov_b32 s5, 4096
  v_mul_lo_u32 v5, v5, s5
  v_add_u32 v5, v5, v10
  v_add_u32 v30, s6, v5
  v_add_u32 v31, 32768, v30
  s_lshr_b32 s4, s81, 2
  s_mul_i32 s4, s4, 11
  s_lshr_b32 s4, s4, 2
  s_and_b32 s5, s81, 3
  s_mul_i32 s5, s5, 11
  s_lshr_b32 s5, s5, 1
  s_add_u32 s4, s4, s5
  s_sub_u32 s5, s4, 22
  s_cmp_ge_u32 s4, 22
  s_cselect_b32 s4, s5, s4
  s_sub_u32 s5, s4, 22
  s_cmp_ge_u32 s4, 22
  s_cselect_b32 s71, s5, s4
  s_lshl_b32 s72, s71, 18
  s_add_u32 m0, s88, 81920
  s_nop 0
  buffer_load_dwordx4 v30, s[24:27], s72 offen  lds
  s_add_u32 m0, s88, 82944
  s_nop 0
  buffer_load_dwordx4 v31, s[24:27], s72 offen  lds
  s_add_u32 s72, s72, 262144
  s_cmp_eq_u32 s72, 5767168
  s_cselect_b32 s72, 0, s72
  s_add_u32 m0, s88, 98304
  s_nop 0
  buffer_load_dwordx4 v30, s[24:27], s72 offen  lds
  s_add_u32 m0, s88, 99328
  s_nop 0
  buffer_load_dwordx4 v31, s[24:27], s72 offen  lds
  s_add_u32 s72, s72, 262144
  s_cmp_eq_u32 s72, 5767168
  s_cselect_b32 s72, 0, s72
  s_add_u32 m0, s88, 114688
  s_nop 0
  buffer_load_dwordx4 v30, s[24:27], s72 offen  lds
  s_add_u32 m0, s88, 115712
  s_nop 0
  buffer_load_dwordx4 v31, s[24:27], s72 offen  lds
  s_add_u32 s72, s72, 262144
  s_cmp_eq_u32 s72, 5767168
  s_cselect_b32 s72, 0, s72
  s_add_u32 m0, s88, 0
  s_nop 0
  buffer_load_dwordx4 v30, s[24:27], s72 offen  lds
  s_add_u32 m0, s88, 1024
  s_nop 0
  buffer_load_dwordx4 v31, s[24:27], s72 offen  lds
  s_add_u32 s72, s72, 262144
  s_cmp_eq_u32 s72, 5767168
  s_cselect_b32 s72, 0, s72
  s_add_u32 m0, s88, 16384
  s_nop 0
  buffer_load_dwordx4 v30, s[24:27], s72 offen  lds
  s_add_u32 m0, s88, 17408
  s_nop 0
  buffer_load_dwordx4 v31, s[24:27], s72 offen  lds
  s_add_u32 s72, s72, 262144
  s_cmp_eq_u32 s72, 5767168
  s_cselect_b32 s72, 0, s72
  s_add_u32 m0, s88, 32768
  s_nop 0
  buffer_load_dwordx4 v30, s[24:27], s72 offen  lds
  s_waitcnt vmcnt(10)
  s_add_u32 m0, s88, 33792
  s_nop 0
  buffer_load_dwordx4 v31, s[24:27], s72 offen  lds
  s_add_u32 s72, s72, 262144
  s_cmp_eq_u32 s72, 5767168
  s_cselect_b32 s72, 0, s72
  s_waitcnt vmcnt(10)
  s_add_u32 m0, s88, 49152
  s_nop 0
  buffer_load_dwordx4 v30, s[24:27], s72 offen  lds
  s_waitcnt vmcnt(10)
  s_add_u32 m0, s88, 50176
  s_nop 0
  buffer_load_dwordx4 v31, s[24:27], s72 offen  lds
  s_add_u32 s72, s72, 262144
  s_cmp_eq_u32 s72, 5767168
  s_cselect_b32 s72, 0, s72
  s_waitcnt vmcnt(10)
  s_add_u32 m0, s88, 65536
  s_nop 0
  buffer_load_dwordx4 v30, s[24:27], s72 offen  lds
  s_waitcnt vmcnt(10)
  s_add_u32 m0, s88, 66560
  s_nop 0
  buffer_load_dwordx4 v31, s[24:27], s72 offen  lds
  s_add_u32 s72, s72, 262144
  s_cmp_eq_u32 s72, 5767168
  s_cselect_b32 s72, 0, s72
  s_cmp_lg_u32 s79, 0
  s_cbranch_scc1 L_gp_62
  s_mov_b32 s7, 131072
  v_min_u32 v13, 2, v1
  v_add_u32 v13, s71, v13
  v_subrev_u32 v5, 22, v13
  v_cmp_le_u32 vcc, 22, v13
  s_nop 1
  v_cndmask_b32 v13, v13, v5, vcc
  s_lshl_b32 s4, s90, 11
  s_add_u32 s4, s4, 6520832
  v_lshlrev_b32 v13, 6, v13
  v_add_u32 v13, s4, v13
L_gs_63:
  buffer_load_dword v12, v13, s[28:31], 0 offen sc1
  s_waitcnt vmcnt(0)
  v_cmp_gt_u32 vcc, 1, v12
  s_cbranch_vccz L_go_64
  s_sub_u32 s7, s7, 1
  s_cmp_eq_u32 s7, 0
  s_cbranch_scc1 L_go_64
  s_sleep 1
  s_branch L_gs_63
L_go_64:
  v_mov_b32 v5, 162848
  v_mov_b32 v6, 1
  ds_write_b32 v5, v6
  s_branch L_gf_65
L_gp_62:
  v_mov_b32 v5, 162848
  s_mov_b32 s7, 1048576
L_ls_66:
  ds_read_b32 v6, v5
  s_waitcnt lgkmcnt(0)
  v_readfirstlane_b32 s4, v6
  s_nop 3
  s_cmp_ge_u32 s4, 1
  s_cbranch_scc1 L_lo_67
  s_sub_u32 s7, s7, 1
  s_cmp_eq_u32 s7, 0
  s_cbranch_scc1 L_lo_67
  s_sleep 1
  s_branch L_ls_66
L_lo_67:
L_gf_65:
  s_branch L_l_merge
L_l_b1:
  s_lshl_b32 s6, s87, 7
  s_lshl_b32 s4, s79, 4
  v_add_u32 v5, s4, v11
  s_mov_b32 s5, 2752
  v_mul_lo_u32 v5, v5, s5
  v_add_u32 v5, v5, v10
  v_add_u32 v24, s6, v5
  v_add_u32 v25, 22016, v24
  s_lshl_b32 s4, s79, 14
  s_lshl_b32 s5, s86, 10
  s_add_u32 s4, s4, s5
  s_add_u32 s4, s4, 0
  v_lshlrev_b32 v5, 4, v1
  v_add_u32 v26, s4, v5
  v_add_u32 v27, 8192, v26
  s_and_b32 s4, s81, 3
  s_mul_i32 s4, s4, 8
  s_lshr_b32 s5, s81, 2
  s_mul_i32 s5, s5, 5
  s_add_u32 s4, s4, s5
  s_and_b32 s5, s80, 1
  s_mul_i32 s5, s5, 4
  s_add_u32 s4, s4, s5
  s_and_b32 s4, s4, 31
  s_mul_i32 s67, s4, 176128
  s_lshl_b32 s68, s4, 16
  s_barrier
  s_waitcnt vmcnt(10)
  s_add_u32 m0, s88, 81920
  s_nop 0
  buffer_load_dwordx4 v24, s[20:23], s67 offen  lds
  s_waitcnt vmcnt(10)
  s_add_u32 m0, s88, 82944
  s_nop 0
  buffer_load_dwordx4 v25, s[20:23], s67 offen  lds
  s_add_u32 s67, s67, 176128
  s_cmp_eq_u32 s67, 5636096
  s_cselect_b32 s67, 0, s67
  s_barrier
  s_waitcnt vmcnt(10)
  s_add_u32 m0, s88, 98304
  s_nop 0
  buffer_load_dwordx4 v24, s[20:23], s67 offen  lds
  s_waitcnt vmcnt(10)
  s_add_u32 m0, s88, 99328
  s_nop 0
  buffer_load_dwordx4 v25, s[20:23], s67 offen  lds
  s_add_u32 s67, s67, 176128
  s_cmp_eq_u32 s67, 5636096
  s_cselect_b32 s67, 0, s67
  s_waitcnt vmcnt(10)
  s_barrier
  s_add_u32 m0, s88, 114688
  s_nop 0
  buffer_load_dwordx4 v24, s[20:23], s67 offen  lds
  s_waitcnt vmcnt(10)
  s_add_u32 m0, s88, 115712
  s_nop 0
  buffer_load_dwordx4 v25, s[20:23], s67 offen  lds
  s_add_u32 s67, s67, 176128
  s_cmp_eq_u32 s67, 5636096
  s_cselect_b32 s67, 0, s67
  s_waitcnt vmcnt(6)
  s_barrier
  s_add_u32 m0, s88, 0
  s_nop 0
  buffer_load_dwordx4 v24, s[20:23], s67 offen  lds
  s_add_u32 m0, s88, 1024
  s_nop 0
  buffer_load_dwordx4 v25, s[20:23], s67 offen  lds
  s_add_u32 s67, s67, 176128
  s_cmp_eq_u32 s67, 5636096
  s_cselect_b32 s67, 0, s67
  s_barrier
  s_add_u32 m0, s88, 16384
  s_nop 0
  buffer_load_dwordx4 v24, s[20:23], s67 offen  lds
  s_add_u32 m0, s88, 17408
  s_nop 0
  buffer_load_dwordx4 v25, s[20:23], s67 offen  lds
  s_add_u32 s67, s67, 176128
  s_cmp_eq_u32 s67, 5636096
  s_cselect_b32 s67, 0, s67
  s_add_u32 m0, s88, 32768
  s_nop 0
  buffer_load_dwordx4 v24, s[20:23], s67 offen  lds
  s_waitcnt vmcnt(10)
  s_add_u32 m0, s88, 33792
  s_nop 0
  buffer_load_dwordx4 v25, s[20:23], s67 offen  lds
  s_add_u32 s67, s67, 176128
  s_cmp_eq_u32 s67, 5636096
  s_cselect_b32 s67, 0, s67
  s_cmp_lg_u32 s79, 0
  s_cbranch_scc1 L_pb_23
  v_and_b32 v13, 7, v1
  v_lshlrev_b32 v13, 5, v13
  global_load_dword v12, v13, s[74:75] sc1
L_pb_23:
  s_waitcnt vmcnt(10)
  s_add_u32 m0, s88, 49152
  s_nop 0
  buffer_load_dwordx4 v24, s[20:23], s67 offen  lds
  s_waitcnt vmcnt(10)
  s_add_u32 m0, s88, 50176
  s_nop 0
  buffer_load_dwordx4 v25, s[20:23], s67 offen  lds
  s_add_u32 s67, s67, 176128
  s_cmp_eq_u32 s67, 5636096
  s_cselect_b32 s67, 0, s67
  s_waitcnt vmcnt(10)
  s_add_u32 m0, s88, 65536
  s_nop 0
  buffer_load_dwordx4 v24, s[20:23], s67 offen  lds
  s_waitcnt vmcnt(10)
  s_add_u32 m0, s88, 66560
  s_nop 0
  buffer_load_dwordx4 v25, s[20:23], s67 offen  lds
  s_add_u32 s67, s67, 176128
  s_cmp_eq_u32 s67, 5636096
  s_cselect_b32 s67, 0, s67
  s_cmp_lg_u32 s79, 0
  s_cbranch_scc1 L_gp_24
  s_mov_b32 s7, 131072
  s_waitcnt vmcnt(4)
  v_cmp_gt_u32 vcc, 32, v12
  s_cbranch_vccz L_go_26
L_gs_25:
  global_load_dword v12, v13, s[74:75] sc1
  s_waitcnt vmcnt(0)
  v_cmp_gt_u32 vcc, 32, v12
  s_cbranch_vccz L_go_26
  s_sub_u32 s7, s7, 1
  s_cmp_eq_u32 s7, 0
  s_cbranch_scc1 L_go_26
  s_sleep 1
  s_branch L_gs_25
L_go_26:
  v_mov_b32 v5, 162836
  v_mov_b32 v6, 1
  ds_write_b32 v5, v6
  s_branch L_gf_27
L_gp_24:
  v_mov_b32 v5, 162836
  s_mov_b32 s7, 1048576
L_ls_28:
  ds_read_b32 v6, v5
  s_waitcnt lgkmcnt(0)
  v_readfirstlane_b32 s4, v6
  s_nop 3
  s_cmp_ge_u32 s4, 1
  s_cbranch_scc1 L_lo_29
  s_sub_u32 s7, s7, 1
  s_cmp_eq_u32 s7, 0
  s_cbranch_scc1 L_lo_29
  s_sleep 1
  s_branch L_ls_28
L_lo_29:
L_gf_27:
  s_waitcnt vmcnt(10)
  s_add_u32 m0, s88, 90112
  s_nop 0
  buffer_load_dwordx4 v26, s[28:31], s68 offen  lds
  s_waitcnt vmcnt(10)
  s_add_u32 m0, s88, 91136
  s_nop 0
  buffer_load_dwordx4 v27, s[28:31], s68 offen  lds
  s_add_u32 s68, s68, 65536
  s_cmp_eq_u32 s68, 2097152
  s_cselect_b32 s68, 0, s68
  s_waitcnt vmcnt(10)
  s_add_u32 m0, s88, 106496
  s_nop 0
  buffer_load_dwordx4 v26, s[28:31], s68 offen  lds
  s_waitcnt vmcnt(10)
  s_add_u32 m0, s88, 107520
  s_nop 0
  buffer_load_dwordx4 v27, s[28:31], s68 offen  lds
  s_add_u32 s68, s68, 65536
  s_cmp_eq_u32 s68, 2097152
  s_cselect_b32 s68, 0, s68
  s_waitcnt vmcnt(10)
  s_add_u32 m0, s88, 122880
  s_nop 0
  buffer_load_dwordx4 v26, s[28:31], s68 offen  lds
  s_waitcnt vmcnt(10)
  s_add_u32 m0, s88, 123904
  s_nop 0
  buffer_load_dwordx4 v27, s[28:31], s68 offen  lds
  s_add_u32 s68, s68, 65536
  s_cmp_eq_u32 s68, 2097152
  s_cselect_b32 s68, 0, s68
  s_waitcnt vmcnt(4)
  s_barrier
  s_add_u32 m0, s88, 8192
  s_nop 0
  buffer_load_dwordx4 v26, s[28:31], s68 offen  lds
  s_add_u32 m0, s88, 9216
  s_nop 0
  buffer_load_dwordx4 v27, s[28:31], s68 offen  lds
  s_add_u32 s68, s68, 65536
  s_cmp_eq_u32 s68, 2097152
  s_cselect_b32 s68, 0, s68
  s_add_u32 m0, s88, 24576
  s_nop 0
  buffer_load_dwordx4 v26, s[28:31], s68 offen  lds
  s_add_u32 m0, s88, 25600
  s_nop 0
  buffer_load_dwordx4 v27, s[28:31], s68 offen  lds
  s_add_u32 s68, s68, 65536
  s_cmp_eq_u32 s68, 2097152
  s_cselect_b32 s68, 0, s68
  s_add_u32 m0, s88, 40960
  s_nop 0
  buffer_load_dwordx4 v26, s[28:31], s68 offen  lds
  s_add_u32 m0, s88, 41984
  s_nop 0
  buffer_load_dwordx4 v27, s[28:31], s68 offen  lds
  s_add_u32 s68, s68, 65536
  s_cmp_eq_u32 s68, 2097152
  s_cselect_b32 s68, 0, s68
  s_waitcnt vmcnt(8)
  s_barrier
  s_add_u32 m0, s88, 57344
  s_nop 0
  buffer_load_dwordx4 v26, s[28:31], s68 offen  lds
  s_add_u32 m0, s88, 58368
  s_nop 0
  buffer_load_dwordx4 v27, s[28:31], s68 offen  lds
  s_add_u32 s68, s68, 65536
  s_cmp_eq_u32 s68, 2097152
  s_cselect_b32 s68, 0, s68
  s_add_u32 m0, s88, 73728
  s_nop 0
  buffer_load_dwordx4 v26, s[28:31], s68 offen  lds
  s_waitcnt vmcnt(10)
  s_add_u32 m0, s88, 74752
  s_nop 0
  buffer_load_dwordx4 v27, s[28:31], s68 offen  lds
  s_add_u32 s68, s68, 65536
  s_cmp_eq_u32 s68, 2097152
  s_cselect_b32 s68, 0, s68
  s_waitcnt vmcnt(10)
  s_barrier
  s_add_u32 m0, s88, 81920
  s_nop 0
  buffer_load_dwordx4 v24, s[20:23], s67 offen  lds
  s_waitcnt vmcnt(10)
  s_add_u32 m0, s88, 82944
  s_nop 0
  buffer_load_dwordx4 v25, s[20:23], s67 offen  lds
  s_add_u32 s67, s67, 176128
  s_cmp_eq_u32 s67, 5636096
  s_cselect_b32 s67, 0, s67
  s_waitcnt vmcnt(10)
  s_add_u32 m0, s88, 90112
  s_nop 0
  buffer_load_dwordx4 v26, s[28:31], s68 offen  lds
  s_waitcnt vmcnt(10)
  s_add_u32 m0, s88, 91136
  s_nop 0
  buffer_load_dwordx4 v27, s[28:31], s68 offen  lds
  s_add_u32 s68, s68, 65536
  s_cmp_eq_u32 s68, 2097152
  s_cselect_b32 s68, 0, s68
  s_barrier
  s_waitcnt vmcnt(10)
  s_add_u32 m0, s88, 98304
  s_nop 0
  buffer_load_dwordx4 v24, s[20:23], s67 offen  lds
  s_waitcnt vmcnt(10)
  s_add_u32 m0, s88, 99328
  s_nop 0
  buffer_load_dwordx4 v25, s[20:23], s67 offen  lds
  s_add_u32 s67, s67, 176128
  s_cmp_eq_u32 s67, 5636096
  s_cselect_b32 s67, 0, s67
  s_waitcnt vmcnt(10)
  s_add_u32 m0, s88, 106496
  s_nop 0
  buffer_load_dwordx4 v26, s[28:31], s68 offen  lds
  s_waitcnt vmcnt(10)
  s_add_u32 m0, s88, 107520
  s_nop 0
  buffer_load_dwordx4 v27, s[28:31], s68 offen  lds
  s_add_u32 s68, s68, 65536
  s_cmp_eq_u32 s68, 2097152
  s_cselect_b32 s68, 0, s68
  s_barrier
  s_waitcnt vmcnt(10)
  s_add_u32 m0, s88, 114688
  s_nop 0
  buffer_load_dwordx4 v24, s[20:23], s67 offen  lds
  s_waitcnt vmcnt(10)
  s_add_u32 m0, s88, 115712
  s_nop 0
  buffer_load_dwordx4 v25, s[20:23], s67 offen  lds
  s_add_u32 s67, s67, 176128
  s_cmp_eq_u32 s67, 5636096
  s_cselect_b32 s67, 0, s67
  s_waitcnt vmcnt(10)
  s_add_u32 m0, s88, 122880
  s_nop 0
  buffer_load_dwordx4 v26, s[28:31], s68 offen  lds
  s_waitcnt vmcnt(10)
  s_add_u32 m0, s88, 123904
  s_nop 0
  buffer_load_dwordx4 v27, s[28:31], s68 offen  lds
  s_add_u32 s68, s68, 65536
  s_cmp_eq_u32 s68, 2097152
  s_cselect_b32 s68, 0, s68
  s_barrier
  s_waitcnt vmcnt(10)
  s_add_u32 m0, s88, 0
  s_nop 0
  buffer_load_dwordx4 v24, s[20:23], s67 offen  lds
  s_waitcnt vmcnt(10)
  s_add_u32 m0, s88, 1024
  s_nop 0
  buffer_load_dwordx4 v25, s[20:23], s67 offen  lds
  s_add_u32 s67, s67, 176128
  s_cmp_eq_u32 s67, 5636096
  s_cselect_b32 s67, 0, s67
  s_waitcnt vmcnt(10)
  s_add_u32 m0, s88, 8192
  s_nop 0
  buffer_load_dwordx4 v26, s[28:31], s68 offen  lds
  s_waitcnt vmcnt(10)
  s_add_u32 m0, s88, 9216
  s_nop 0
  buffer_load_dwordx4 v27, s[28:31], s68 offen  lds
  s_add_u32 s68, s68, 65536
  s_cmp_eq_u32 s68, 2097152
  s_cselect_b32 s68, 0, s68
  s_barrier
  s_waitcnt vmcnt(10)
  s_add_u32 m0, s88, 16384
  s_nop 0
  buffer_load_dwordx4 v24, s[20:23], s67 offen  lds
  s_waitcnt vmcnt(10)
  s_add_u32 m0, s88, 17408
  s_nop 0
  buffer_load_dwordx4 v25, s[20:23], s67 offen  lds
  s_add_u32 s67, s67, 176128
  s_cmp_eq_u32 s67, 5636096
  s_cselect_b32 s67, 0, s67
  s_waitcnt vmcnt(10)
  s_add_u32 m0, s88, 24576
  s_nop 0
  buffer_load_dwordx4 v26, s[28:31], s68 offen  lds
  s_waitcnt vmcnt(10)
  s_add_u32 m0, s88, 25600
  s_nop 0
  buffer_load_dwordx4 v27, s[28:31], s68 offen  lds
  s_add_u32 s68, s68, 65536
  s_cmp_eq_u32 s68, 2097152
  s_cselect_b32 s68, 0, s68
  s_barrier
  s_waitcnt vmcnt(10)
  s_add_u32 m0, s88, 32768
  s_nop 0
  buffer_load_dwordx4 v24, s[20:23], s67 offen  lds
  s_waitcnt vmcnt(10)
  s_add_u32 m0, s88, 33792
  s_nop 0
  buffer_load_dwordx4 v25, s[20:23], s67 offen  lds
  s_add_u32 s67, s67, 176128
  s_cmp_eq_u32 s67, 5636096
  s_cselect_b32 s67, 0, s67
  s_waitcnt vmcnt(10)
  s_add_u32 m0, s88, 40960
  s_nop 0
  buffer_load_dwordx4 v26, s[28:31], s68 offen  lds
  s_waitcnt vmcnt(10)
  s_add_u32 m0, s88, 41984
  s_nop 0
  buffer_load_dwordx4 v27, s[28:31], s68 offen  lds
  s_add_u32 s68, s68, 65536
  s_cmp_eq_u32 s68, 2097152
  s_cselect_b32 s68, 0, s68
  s_barrier
  s_waitcnt vmcnt(10)
  s_add_u32 m0, s88, 49152
  s_nop 0
  buffer_load_dwordx4 v24, s[20:23], s67 offen  lds
  s_waitcnt vmcnt(10)
  s_add_u32 m0, s88, 50176
  s_nop 0
  buffer_load_dwordx4 v25, s[20:23], s67 offen  lds
  s_add_u32 s67, s67, 176128
  s_cmp_eq_u32 s67, 5636096
  s_cselect_b32 s67, 0, s67
  s_waitcnt vmcnt(10)
  s_add_u32 m0, s88, 57344
  s_nop 0
  buffer_load_dwordx4 v26, s[28:31], s68 offen  lds
  s_waitcnt vmcnt(10)
  s_add_u32 m0, s88, 58368
  s_nop 0
  buffer_load_dwordx4 v27, s[28:31], s68 offen  lds
  s_add_u32 s68, s68, 65536
  s_cmp_eq_u32 s68, 2097152
  s_cselect_b32 s68, 0, s68
  s_barrier
  s_waitcnt vmcnt(10)
  s_add_u32 m0, s88, 65536
  s_nop 0
  buffer_load_dwordx4 v24, s[20:23], s67 offen  lds
  s_waitcnt vmcnt(10)
  s_add_u32 m0, s88, 66560
  s_nop 0
  buffer_load_dwordx4 v25, s[20:23], s67 offen  lds
  s_add_u32 s67, s67, 176128
  s_cmp_eq_u32 s67, 5636096
  s_cselect_b32 s67, 0, s67
  s_waitcnt vmcnt(10)
  s_add_u32 m0, s88, 73728
  s_nop 0
  buffer_load_dwordx4 v26, s[28:31], s68 offen  lds
  s_waitcnt vmcnt(10)
  s_add_u32 m0, s88, 74752
  s_nop 0
  buffer_load_dwordx4 v27, s[28:31], s68 offen  lds
  s_add_u32 s68, s68, 65536
  s_cmp_eq_u32 s68, 2097152
  s_cselect_b32 s68, 0, s68
  s_barrier
  s_waitcnt vmcnt(10)
  s_add_u32 m0, s88, 81920
  s_nop 0
  buffer_load_dwordx4 v24, s[20:23], s67 offen  lds
  s_waitcnt vmcnt(10)
  s_add_u32 m0, s88, 82944
  s_nop 0
  buffer_load_dwordx4 v25, s[20:23], s67 offen  lds
  s_add_u32 s67, s67, 176128
  s_cmp_eq_u32 s67, 5636096
  s_cselect_b32 s67, 0, s67
  s_waitcnt vmcnt(10)
  s_add_u32 m0, s88, 90112
  s_nop 0
  buffer_load_dwordx4 v26, s[28:31], s68 offen  lds
  s_waitcnt vmcnt(10)
  s_add_u32 m0, s88, 91136
  s_nop 0
  buffer_load_dwordx4 v27, s[28:31], s68 offen  lds
  s_add_u32 s68, s68, 65536
  s_cmp_eq_u32 s68, 2097152
  s_cselect_b32 s68, 0, s68
  s_barrier
  s_waitcnt vmcnt(10)
  s_add_u32 m0, s88, 98304
  s_nop 0
  buffer_load_dwordx4 v24, s[20:23], s67 offen  lds
  s_waitcnt vmcnt(10)
  s_add_u32 m0, s88, 99328
  s_nop 0
  buffer_load_dwordx4 v25, s[20:23], s67 offen  lds
  s_add_u32 s67, s67, 176128
  s_cmp_eq_u32 s67, 5636096
  s_cselect_b32 s67, 0, s67
  s_waitcnt vmcnt(10)
  s_add_u32 m0, s88, 106496
  s_nop 0
  buffer_load_dwordx4 v26, s[28:31], s68 offen  lds
  s_waitcnt vmcnt(10)
  s_add_u32 m0, s88, 107520
  s_nop 0
  buffer_load_dwordx4 v27, s[28:31], s68 offen  lds
  s_add_u32 s68, s68, 65536
  s_cmp_eq_u32 s68, 2097152
  s_cselect_b32 s68, 0, s68
  s_barrier
  s_waitcnt vmcnt(10)
  s_add_u32 m0, s88, 114688
  s_nop 0
  buffer_load_dwordx4 v24, s[20:23], s67 offen  lds
  s_waitcnt vmcnt(10)
  s_add_u32 m0, s88, 115712
  s_nop 0
  buffer_load_dwordx4 v25, s[20:23], s67 offen  lds
  s_add_u32 s67, s67, 176128
  s_cmp_eq_u32 s67, 5636096
  s_cselect_b32 s67, 0, s67
  s_waitcnt vmcnt(10)
  s_add_u32 m0, s88, 122880
  s_nop 0
  buffer_load_dwordx4 v26, s[28:31], s68 offen  lds
  s_waitcnt vmcnt(10)
  s_add_u32 m0, s88, 123904
  s_nop 0
  buffer_load_dwordx4 v27, s[28:31], s68 offen  lds
  s_add_u32 s68, s68, 65536
  s_cmp_eq_u32 s68, 2097152
  s_cselect_b32 s68, 0, s68
  s_barrier
  s_waitcnt vmcnt(10)
  s_add_u32 m0, s88, 0
  s_nop 0
  buffer_load_dwordx4 v24, s[20:23], s67 offen  lds
  s_waitcnt vmcnt(10)
  s_add_u32 m0, s88, 1024
  s_nop 0
  buffer_load_dwordx4 v25, s[20:23], s67 offen  lds
  s_add_u32 s67, s67, 176128
  s_cmp_eq_u32 s67, 5636096
  s_cselect_b32 s67, 0, s67
  s_waitcnt vmcnt(10)
  s_add_u32 m0, s88, 8192
  s_nop 0
  buffer_load_dwordx4 v26, s[28:31], s68 offen  lds
  s_waitcnt vmcnt(10)
  s_add_u32 m0, s88, 9216
  s_nop 0
  buffer_load_dwordx4 v27, s[28:31], s68 offen  lds
  s_add_u32 s68, s68, 65536
  s_cmp_eq_u32 s68, 2097152
  s_cselect_b32 s68, 0, s68
  s_barrier
  s_waitcnt vmcnt(10)
  s_add_u32 m0, s88, 16384
  s_nop 0
  buffer_load_dwordx4 v24, s[20:23], s67 offen  lds
  s_waitcnt vmcnt(10)
  s_add_u32 m0, s88, 17408
  s_nop 0
  buffer_load_dwordx4 v25, s[20:23], s67 offen  lds
  s_add_u32 s67, s67, 176128
  s_cmp_eq_u32 s67, 5636096
  s_cselect_b32 s67, 0, s67
  s_waitcnt vmcnt(10)
  s_add_u32 m0, s88, 24576
  s_nop 0
  buffer_load_dwordx4 v26, s[28:31], s68 offen  lds
  s_waitcnt vmcnt(10)
  s_add_u32 m0, s88, 25600
  s_nop 0
  buffer_load_dwordx4 v27, s[28:31], s68 offen  lds
  s_add_u32 s68, s68, 65536
  s_cmp_eq_u32 s68, 2097152
  s_cselect_b32 s68, 0, s68
  s_barrier
  s_waitcnt vmcnt(10)
  s_add_u32 m0, s88, 32768
  s_nop 0
  buffer_load_dwordx4 v24, s[20:23], s67 offen  lds
  s_waitcnt vmcnt(10)
  s_add_u32 m0, s88, 33792
  s_nop 0
  buffer_load_dwordx4 v25, s[20:23], s67 offen  lds
  s_add_u32 s67, s67, 176128
  s_cmp_eq_u32 s67, 5636096
  s_cselect_b32 s67, 0, s67
  s_waitcnt vmcnt(10)
  s_add_u32 m0, s88, 40960
  s_nop 0
  buffer_load_dwordx4 v26, s[28:31], s68 offen  lds
  s_waitcnt vmcnt(10)
  s_add_u32 m0, s88, 41984
  s_nop 0
  buffer_load_dwordx4 v27, s[28:31], s68 offen  lds
  s_add_u32 s68, s68, 65536
  s_cmp_eq_u32 s68, 2097152
  s_cselect_b32 s68, 0, s68
  s_barrier
  s_waitcnt vmcnt(10)
  s_add_u32 m0, s88, 49152
  s_nop 0
  buffer_load_dwordx4 v24, s[20:23], s67 offen  lds
  s_waitcnt vmcnt(10)
  s_add_u32 m0, s88, 50176
  s_nop 0
  buffer_load_dwordx4 v25, s[20:23], s67 offen  lds
  s_add_u32 s67, s67, 176128
  s_cmp_eq_u32 s67, 5636096
  s_cselect_b32 s67, 0, s67
  s_waitcnt vmcnt(10)
  s_add_u32 m0, s88, 57344
  s_nop 0
  buffer_load_dwordx4 v26, s[28:31], s68 offen  lds
  s_waitcnt vmcnt(10)
  s_add_u32 m0, s88, 58368
  s_nop 0
  buffer_load_dwordx4 v27, s[28:31], s68 offen  lds
  s_add_u32 s68, s68, 65536
  s_cmp_eq_u32 s68, 2097152
  s_cselect_b32 s68, 0, s68
  s_barrier
  s_waitcnt vmcnt(10)
  s_add_u32 m0, s88, 65536
  s_nop 0
  buffer_load_dwordx4 v24, s[20:23], s67 offen  lds
  s_waitcnt vmcnt(10)
  s_add_u32 m0, s88, 66560
  s_nop 0
  buffer_load_dwordx4 v25, s[20:23], s67 offen  lds
  s_add_u32 s67, s67, 176128
  s_cmp_eq_u32 s67, 5636096
  s_cselect_b32 s67, 0, s67
  s_waitcnt vmcnt(10)
  s_add_u32 m0, s88, 73728
  s_nop 0
  buffer_load_dwordx4 v26, s[28:31], s68 offen  lds
  s_waitcnt vmcnt(10)
  s_add_u32 m0, s88, 74752
  s_nop 0
  buffer_load_dwordx4 v27, s[28:31], s68 offen  lds
  s_add_u32 s68, s68, 65536
  s_cmp_eq_u32 s68, 2097152
  s_cselect_b32 s68, 0, s68
  s_barrier
  s_waitcnt vmcnt(10)
  s_add_u32 m0, s88, 81920
  s_nop 0
  buffer_load_dwordx4 v24, s[20:23], s67 offen  lds
  s_waitcnt vmcnt(10)
  s_add_u32 m0, s88, 82944
  s_nop 0
  buffer_load_dwordx4 v25, s[20:23], s67 offen  lds
  s_add_u32 s67, s67, 176128
  s_cmp_eq_u32 s67, 5636096
  s_cselect_b32 s67, 0, s67
  s_waitcnt vmcnt(10)
  s_add_u32 m0, s88, 90112
  s_nop 0
  buffer_load_dwordx4 v26, s[28:31], s68 offen  lds
  s_waitcnt vmcnt(10)
  s_add_u32 m0, s88, 91136
  s_nop 0
  buffer_load_dwordx4 v27, s[28:31], s68 offen  lds
  s_add_u32 s68, s68, 65536
  s_cmp_eq_u32 s68, 2097152
  s_cselect_b32 s68, 0, s68
  s_barrier
  s_waitcnt vmcnt(10)
  s_add_u32 m0, s88, 98304
  s_nop 0
  buffer_load_dwordx4 v24, s[20:23], s67 offen  lds
  s_waitcnt vmcnt(10)
  s_add_u32 m0, s88, 99328
  s_nop 0
  buffer_load_dwordx4 v25, s[20:23], s67 offen  lds
  s_add_u32 s67, s67, 176128
  s_cmp_eq_u32 s67, 5636096
  s_cselect_b32 s67, 0, s67
  s_waitcnt vmcnt(10)
  s_add_u32 m0, s88, 106496
  s_nop 0
  buffer_load_dwordx4 v26, s[28:31], s68 offen  lds
  s_waitcnt vmcnt(10)
  s_add_u32 m0, s88, 107520
  s_nop 0
  buffer_load_dwordx4 v27, s[28:31], s68 offen  lds
  s_add_u32 s68, s68, 65536
  s_cmp_eq_u32 s68, 2097152
  s_cselect_b32 s68, 0, s68
  s_barrier
  s_waitcnt vmcnt(10)
  s_add_u32 m0, s88, 114688
  s_nop 0
  buffer_load_dwordx4 v24, s[20:23], s67 offen  lds
  s_waitcnt vmcnt(10)
  s_add_u32 m0, s88, 115712
  s_nop 0
  buffer_load_dwordx4 v25, s[20:23], s67 offen  lds
  s_add_u32 s67, s67, 176128
  s_cmp_eq_u32 s67, 5636096
  s_cselect_b32 s67, 0, s67
  s_waitcnt vmcnt(10)
  s_add_u32 m0, s88, 122880
  s_nop 0
  buffer_load_dwordx4 v26, s[28:31], s68 offen  lds
  s_waitcnt vmcnt(10)
  s_add_u32 m0, s88, 123904
  s_nop 0
  buffer_load_dwordx4 v27, s[28:31], s68 offen  lds
  s_add_u32 s68, s68, 65536
  s_cmp_eq_u32 s68, 2097152
  s_cselect_b32 s68, 0, s68
  s_barrier
  s_waitcnt vmcnt(10)
  s_add_u32 m0, s88, 0
  s_nop 0
  buffer_load_dwordx4 v24, s[20:23], s67 offen  lds
  s_waitcnt vmcnt(10)
  s_add_u32 m0, s88, 1024
  s_nop 0
  buffer_load_dwordx4 v25, s[20:23], s67 offen  lds
  s_add_u32 s67, s67, 176128
  s_cmp_eq_u32 s67, 5636096
  s_cselect_b32 s67, 0, s67
  s_waitcnt vmcnt(10)
  s_add_u32 m0, s88, 8192
  s_nop 0
  buffer_load_dwordx4 v26, s[28:31], s68 offen  lds
  s_waitcnt vmcnt(10)
  s_add_u32 m0, s88, 9216
  s_nop 0
  buffer_load_dwordx4 v27, s[28:31], s68 offen  lds
  s_add_u32 s68, s68, 65536
  s_cmp_eq_u32 s68, 2097152
  s_cselect_b32 s68, 0, s68
  s_barrier
  s_waitcnt vmcnt(10)
  s_add_u32 m0, s88, 16384
  s_nop 0
  buffer_load_dwordx4 v24, s[20:23], s67 offen  lds
  s_waitcnt vmcnt(10)
  s_add_u32 m0, s88, 17408
  s_nop 0
  buffer_load_dwordx4 v25, s[20:23], s67 offen  lds
  s_add_u32 s67, s67, 176128
  s_cmp_eq_u32 s67, 5636096
  s_cselect_b32 s67, 0, s67
  s_waitcnt vmcnt(10)
  s_add_u32 m0, s88, 24576
  s_nop 0
  buffer_load_dwordx4 v26, s[28:31], s68 offen  lds
  s_waitcnt vmcnt(10)
  s_add_u32 m0, s88, 25600
  s_nop 0
  buffer_load_dwordx4 v27, s[28:31], s68 offen  lds
  s_add_u32 s68, s68, 65536
  s_cmp_eq_u32 s68, 2097152
  s_cselect_b32 s68, 0, s68
  s_barrier
  s_waitcnt vmcnt(10)
  s_add_u32 m0, s88, 32768
  s_nop 0
  buffer_load_dwordx4 v24, s[20:23], s67 offen  lds
  s_waitcnt vmcnt(10)
  s_add_u32 m0, s88, 33792
  s_nop 0
  buffer_load_dwordx4 v25, s[20:23], s67 offen  lds
  s_add_u32 s67, s67, 176128
  s_cmp_eq_u32 s67, 5636096
  s_cselect_b32 s67, 0, s67
  s_waitcnt vmcnt(10)
  s_add_u32 m0, s88, 40960
  s_nop 0
  buffer_load_dwordx4 v26, s[28:31], s68 offen  lds
  s_waitcnt vmcnt(10)
  s_add_u32 m0, s88, 41984
  s_nop 0
  buffer_load_dwordx4 v27, s[28:31], s68 offen  lds
  s_add_u32 s68, s68, 65536
  s_cmp_eq_u32 s68, 2097152
  s_cselect_b32 s68, 0, s68
  s_barrier
  s_waitcnt vmcnt(10)
  s_add_u32 m0, s88, 49152
  s_nop 0
  buffer_load_dwordx4 v24, s[20:23], s67 offen  lds
  s_waitcnt vmcnt(10)
  s_add_u32 m0, s88, 50176
  s_nop 0
  buffer_load_dwordx4 v25, s[20:23], s67 offen  lds
  s_add_u32 s67, s67, 176128
  s_cmp_eq_u32 s67, 5636096
  s_cselect_b32 s67, 0, s67
  s_waitcnt vmcnt(10)
  s_add_u32 m0, s88, 57344
  s_nop 0
  buffer_load_dwordx4 v26, s[28:31], s68 offen  lds
  s_waitcnt vmcnt(10)
  s_add_u32 m0, s88, 58368
  s_nop 0
  buffer_load_dwordx4 v27, s[28:31], s68 offen  lds
  s_add_u32 s68, s68, 65536
  s_cmp_eq_u32 s68, 2097152
  s_cselect_b32 s68, 0, s68
  s_barrier
  s_waitcnt vmcnt(10)
  s_add_u32 m0, s88, 65536
  s_nop 0
  buffer_load_dwordx4 v24, s[20:23], s67 offen  lds
  s_waitcnt vmcnt(10)
  s_add_u32 m0, s88, 66560
  s_nop 0
  buffer_load_dwordx4 v25, s[20:23], s67 offen  lds
  s_add_u32 s67, s67, 176128
  s_cmp_eq_u32 s67, 5636096
  s_cselect_b32 s67, 0, s67
  s_waitcnt vmcnt(10)
  s_add_u32 m0, s88, 73728
  s_nop 0
  buffer_load_dwordx4 v26, s[28:31], s68 offen  lds
  s_waitcnt vmcnt(10)
  s_add_u32 m0, s88, 74752
  s_nop 0
  buffer_load_dwordx4 v27, s[28:31], s68 offen  lds
  s_add_u32 s68, s68, 65536
  s_cmp_eq_u32 s68, 2097152
  s_cselect_b32 s68, 0, s68
  s_barrier
  s_lshl_b32 s6, s89, 7
  s_lshl_b32 s4, s79, 4
  v_add_u32 v5, s4, v11
  s_mov_b32 s5, 4096
  v_mul_lo_u32 v5, v5, s5
  v_add_u32 v5, v5, v10
  v_add_u32 v30, s6, v5
  v_add_u32 v31, 32768, v30
  s_lshr_b32 s4, s81, 2
  s_mul_i32 s4, s4, 11
  s_lshr_b32 s4, s4, 2
  s_and_b32 s5, s81, 3
  s_mul_i32 s5, s5, 11
  s_lshr_b32 s5, s5, 1
  s_add_u32 s4, s4, s5
  s_sub_u32 s5, s4, 22
  s_cmp_ge_u32 s4, 22
  s_cselect_b32 s4, s5, s4
  s_sub_u32 s5, s4, 22
  s_cmp_ge_u32 s4, 22
  s_cselect_b32 s71, s5, s4
  s_lshl_b32 s72, s71, 18
  s_waitcnt vmcnt(10)
  s_add_u32 m0, s88, 81920
  s_nop 0
  buffer_load_dwordx4 v30, s[24:27], s72 offen  lds
  s_waitcnt vmcnt(10)
  s_add_u32 m0, s88, 82944
  s_nop 0
  buffer_load_dwordx4 v31, s[24:27], s72 offen  lds
  s_add_u32 s72, s72, 262144
  s_cmp_eq_u32 s72, 5767168
  s_cselect_b32 s72, 0, s72
  s_barrier
  s_waitcnt vmcnt(10)
  s_add_u32 m0, s88, 98304
  s_nop 0
  buffer_load_dwordx4 v30, s[24:27], s72 offen  lds
  s_waitcnt vmcnt(10)
  s_add_u32 m0, s88, 99328
  s_nop 0
  buffer_load_dwordx4 v31, s[24:27], s72 offen  lds
  s_add_u32 s72, s72, 262144
  s_cmp_eq_u32 s72, 5767168
  s_cselect_b32 s72, 0, s72
  s_barrier
  s_waitcnt vmcnt(10)
  s_add_u32 m0, s88, 114688
  s_nop 0
  buffer_load_dwordx4 v30, s[24:27], s72 offen  lds
  s_waitcnt vmcnt(10)
  s_add_u32 m0, s88, 115712
  s_nop 0
  buffer_load_dwordx4 v31, s[24:27], s72 offen  lds
  s_add_u32 s72, s72, 262144
  s_cmp_eq_u32 s72, 5767168
  s_cselect_b32 s72, 0, s72
  s_barrier
  s_waitcnt vmcnt(10)
  s_add_u32 m0, s88, 0
  s_nop 0
  buffer_load_dwordx4 v30, s[24:27], s72 offen  lds
  s_waitcnt vmcnt(10)
  s_add_u32 m0, s88, 1024
  s_nop 0
  buffer_load_dwordx4 v31, s[24:27], s72 offen  lds
  s_add_u32 s72, s72, 262144
  s_cmp_eq_u32 s72, 5767168
  s_cselect_b32 s72, 0, s72
  s_barrier
  s_waitcnt vmcnt(10)
  s_add_u32 m0, s88, 16384
  s_nop 0
  buffer_load_dwordx4 v30, s[24:27], s72 offen  lds
  s_waitcnt vmcnt(10)
  s_add_u32 m0, s88, 17408
  s_nop 0
  buffer_load_dwordx4 v31, s[24:27], s72 offen  lds
  s_add_u32 s72, s72, 262144
  s_cmp_eq_u32 s72, 5767168
  s_cselect_b32 s72, 0, s72
  s_waitcnt vmcnt(10)
  s_barrier
  s_add_u32 m0, s88, 32768
  s_nop 0
  buffer_load_dwordx4 v30, s[24:27], s72 offen  lds
  s_waitcnt vmcnt(10)
  s_add_u32 m0, s88, 33792
  s_nop 0
  buffer_load_dwordx4 v31, s[24:27], s72 offen  lds
  s_add_u32 s72, s72, 262144
  s_cmp_eq_u32 s72, 5767168
  s_cselect_b32 s72, 0, s72
  s_barrier
  s_waitcnt vmcnt(10)
  s_add_u32 m0, s88, 49152
  s_nop 0
  buffer_load_dwordx4 v30, s[24:27], s72 offen  lds
  s_waitcnt vmcnt(10)
  s_add_u32 m0, s88, 50176
  s_nop 0
  buffer_load_dwordx4 v31, s[24:27], s72 offen  lds
  s_add_u32 s72, s72, 262144
  s_cmp_eq_u32 s72, 5767168
  s_cselect_b32 s72, 0, s72
  s_waitcnt vmcnt(10)
  s_add_u32 m0, s88, 65536
  s_nop 0
  buffer_load_dwordx4 v30, s[24:27], s72 offen  lds
  s_waitcnt vmcnt(10)
  s_add_u32 m0, s88, 66560
  s_nop 0
  buffer_load_dwordx4 v31, s[24:27], s72 offen  lds
  s_add_u32 s72, s72, 262144
  s_cmp_eq_u32 s72, 5767168
  s_cselect_b32 s72, 0, s72
  s_cmp_lg_u32 s79, 0
  s_cbranch_scc1 L_gp_30
  s_mov_b32 s7, 131072
  v_min_u32 v13, 2, v1
  v_add_u32 v13, s71, v13
  v_subrev_u32 v5, 22, v13
  v_cmp_le_u32 vcc, 22, v13
  s_nop 1
  v_cndmask_b32 v13, v13, v5, vcc
  s_lshl_b32 s4, s90, 11
  s_add_u32 s4, s4, 6520832
  v_lshlrev_b32 v13, 6, v13
  v_add_u32 v13, s4, v13
L_gs_31:
  buffer_load_dword v12, v13, s[28:31], 0 offen sc1
  s_waitcnt vmcnt(0)
  v_cmp_gt_u32 vcc, 1, v12
  s_cbranch_vccz L_go_32
  s_sub_u32 s7, s7, 1
  s_cmp_eq_u32 s7, 0
  s_cbranch_scc1 L_go_32
  s_sleep 1
  s_branch L_gs_31
L_go_32:
  v_mov_b32 v5, 162848
  v_mov_b32 v6, 1
  ds_write_b32 v5, v6
  s_branch L_gf_33
L_gp_30:
  v_mov_b32 v5, 162848
  s_mov_b32 s7, 1048576
L_ls_34:
  ds_read_b32 v6, v5
  s_waitcnt lgkmcnt(0)
  v_readfirstlane_b32 s4, v6
  s_nop 3
  s_cmp_ge_u32 s4, 1
  s_cbranch_scc1 L_lo_35
  s_sub_u32 s7, s7, 1
  s_cmp_eq_u32 s7, 0
  s_cbranch_scc1 L_lo_35
  s_sleep 1
  s_branch L_ls_34
L_lo_35:
L_gf_33:
L_l_merge:
  s_lshl_b32 s4, s90, 1
  s_lshr_b32 s5, s79, 1
  s_add_u32 s4, s4, s5
  s_mul_i32 s4, s4, 88
  s_and_b32 s5, s79, 1
  s_lshl_b32 s5, s5, 1
  s_add_u32 s4, s4, s5
  s_lshl_b32 s4, s4, 10
  s_add_u32 s4, s4, 2097152
  v_lshlrev_b32 v5, 4, v1
  v_add_u32 v26, s4, v5
  s_lshl_b32 s68, s71, 12
  s_waitcnt vmcnt(10)
  s_add_u32 m0, s88, 90112
  s_nop 0
  buffer_load_dwordx4 v26, s[28:31], s68 offen offset:0 lds
  s_waitcnt vmcnt(10)
  s_add_u32 m0, s88, 90112
  s_nop 0
  buffer_load_dwordx4 v26, s[28:31], s68 offen offset:1024 lds
  s_add_u32 s68, s68, 4096
  s_cmp_eq_u32 s68, 90112
  s_cselect_b32 s68, 0, s68
  s_waitcnt vmcnt(10)
  s_add_u32 m0, s88, 106496
  s_nop 0
  buffer_load_dwordx4 v26, s[28:31], s68 offen offset:0 lds
  s_waitcnt vmcnt(10)
  s_add_u32 m0, s88, 106496
  s_nop 0
  buffer_load_dwordx4 v26, s[28:31], s68 offen offset:1024 lds
  s_add_u32 s68, s68, 4096
  s_cmp_eq_u32 s68, 90112
  s_cselect_b32 s68, 0, s68
  s_waitcnt vmcnt(10)
  s_add_u32 m0, s88, 122880
  s_nop 0
  buffer_load_dwordx4 v26, s[28:31], s68 offen offset:0 lds
  s_waitcnt vmcnt(10)
  s_add_u32 m0, s88, 122880
  s_nop 0
  buffer_load_dwordx4 v26, s[28:31], s68 offen offset:1024 lds
  s_add_u32 s68, s68, 4096
  s_cmp_eq_u32 s68, 90112
  s_cselect_b32 s68, 0, s68
  s_cmp_lg_u32 s79, 0
  s_cbranch_scc1 L_pb_68
  v_min_u32 v13, 7, v1
  v_add_u32 v13, s71, v13
  v_subrev_u32 v5, 22, v13
  v_cmp_le_u32 vcc, 22, v13
  s_nop 1
  v_cndmask_b32 v13, v13, v5, vcc
  s_lshl_b32 s4, s90, 11
  s_add_u32 s4, s4, 6520832
  v_lshlrev_b32 v13, 6, v13
  v_add_u32 v13, s4, v13
  buffer_load_dword v12, v13, s[28:31], 0 offen sc1
L_pb_68:
  s_waitcnt vmcnt(4)
  s_barrier
  s_cmp_lg_u32 s79, 0
  s_cbranch_scc1 L_gp_69
  s_mov_b32 s7, 131072
  s_waitcnt vmcnt(0)
  v_cmp_gt_u32 vcc, 1, v12
  s_cbranch_vccz L_go_71
L_gs_70:
  buffer_load_dword v12, v13, s[28:31], 0 offen sc1
  s_waitcnt vmcnt(0)
  v_cmp_gt_u32 vcc, 1, v12
  s_cbranch_vccz L_go_71
  s_sub_u32 s7, s7, 1
  s_cmp_eq_u32 s7, 0
  s_cbranch_scc1 L_go_71
  s_sleep 1
  s_branch L_gs_70
L_go_71:
  v_mov_b32 v5, 162852
  v_mov_b32 v6, 1
  ds_write_b32 v5, v6
  s_branch L_gf_72
L_gp_69:
  v_mov_b32 v5, 162852
  s_mov_b32 s7, 1048576
L_ls_73:
  ds_read_b32 v6, v5
  s_waitcnt lgkmcnt(0)
  v_readfirstlane_b32 s4, v6
  s_nop 3
  s_cmp_ge_u32 s4, 1
  s_cbranch_scc1 L_lo_74
  s_sub_u32 s7, s7, 1
  s_cmp_eq_u32 s7, 0
  s_cbranch_scc1 L_lo_74
  s_sleep 1
  s_branch L_ls_73
L_lo_74:
L_gf_72:
  s_add_u32 m0, s88, 8192
  s_nop 0
  buffer_load_dwordx4 v26, s[28:31], s68 offen offset:0 lds
  s_add_u32 m0, s88, 8192
  s_nop 0
  buffer_load_dwordx4 v26, s[28:31], s68 offen offset:1024 lds
  s_add_u32 s68, s68, 4096
  s_cmp_eq_u32 s68, 90112
  s_cselect_b32 s68, 0, s68
  s_add_u32 m0, s88, 24576
  s_nop 0
  buffer_load_dwordx4 v26, s[28:31], s68 offen offset:0 lds
  s_add_u32 m0, s88, 24576
  s_nop 0
  buffer_load_dwordx4 v26, s[28:31], s68 offen offset:1024 lds
  s_add_u32 s68, s68, 4096
  s_cmp_eq_u32 s68, 90112
  s_cselect_b32 s68, 0, s68
  s_add_u32 m0, s88, 40960
  s_nop 0
  buffer_load_dwordx4 v26, s[28:31], s68 offen offset:0 lds
  s_add_u32 m0, s88, 40960
  s_nop 0
  buffer_load_dwordx4 v26, s[28:31], s68 offen offset:1024 lds
  s_add_u32 s68, s68, 4096
  s_cmp_eq_u32 s68, 90112
  s_cselect_b32 s68, 0, s68
  s_cmp_lg_u32 s79, 0
  s_cbranch_scc1 L_pb_75
  s_lshl_b32 s4, s90, 11
  s_add_u32 s4, s4, 6520832
  v_min_u32 v13, 21, v1
  v_lshlrev_b32 v13, 6, v13
  v_add_u32 v13, s4, v13
  buffer_load_dword v12, v13, s[28:31], 0 offen sc1
L_pb_75:
  s_waitcnt vmcnt(8)
  s_barrier
  s_add_u32 m0, s88, 57344
  s_nop 0
  buffer_load_dwordx4 v26, s[28:31], s68 offen offset:0 lds
  s_add_u32 m0, s88, 57344
  s_nop 0
  buffer_load_dwordx4 v26, s[28:31], s68 offen offset:1024 lds
  s_add_u32 s68, s68, 4096
  s_cmp_eq_u32 s68, 90112
  s_cselect_b32 s68, 0, s68
  s_waitcnt vmcnt(10)
  s_add_u32 m0, s88, 73728
  s_nop 0
  buffer_load_dwordx4 v26, s[28:31], s68 offen offset:0 lds
  s_waitcnt vmcnt(10)
  s_add_u32 m0, s88, 73728
  s_nop 0
  buffer_load_dwordx4 v26, s[28:31], s68 offen offset:1024 lds
  s_add_u32 s68, s68, 4096
  s_cmp_eq_u32 s68, 90112
  s_cselect_b32 s68, 0, s68
  s_waitcnt vmcnt(10)
  s_barrier
  s_cmp_lg_u32 s79, 0
  s_cbranch_scc1 L_gp_76
  s_mov_b32 s7, 131072
  s_waitcnt vmcnt(4)
  v_cmp_gt_u32 vcc, 1, v12
  s_cbranch_vccz L_go_78
L_gs_77:
  buffer_load_dword v12, v13, s[28:31], 0 offen sc1
  s_waitcnt vmcnt(0)
  v_cmp_gt_u32 vcc, 1, v12
  s_cbranch_vccz L_go_78
  s_sub_u32 s7, s7, 1
  s_cmp_eq_u32 s7, 0
  s_cbranch_scc1 L_go_78
  s_sleep 1
  s_branch L_gs_77
L_go_78:
  v_mov_b32 v5, 162856
  v_mov_b32 v6, 1
  ds_write_b32 v5, v6
  s_branch L_gf_79
L_gp_76:
  v_mov_b32 v5, 162856
  s_mov_b32 s7, 1048576
L_ls_80:
  ds_read_b32 v6, v5
  s_waitcnt lgkmcnt(0)
  v_readfirstlane_b32 s4, v6
  s_nop 3
  s_cmp_ge_u32 s4, 1
  s_cbranch_scc1 L_lo_81
  s_sub_u32 s7, s7, 1
  s_cmp_eq_u32 s7, 0
  s_cbranch_scc1 L_lo_81
  s_sleep 1
  s_branch L_ls_80
L_lo_81:
L_gf_79:
  s_add_u32 m0, s88, 81920
  s_nop 0
  buffer_load_dwordx4 v30, s[24:27], s72 offen  lds
  s_waitcnt vmcnt(10)
  s_add_u32 m0, s88, 82944
  s_nop 0
  buffer_load_dwordx4 v31, s[24:27], s72 offen  lds
  s_add_u32 s72, s72, 262144
  s_cmp_eq_u32 s72, 5767168
  s_cselect_b32 s72, 0, s72
  s_waitcnt vmcnt(10)
  s_add_u32 m0, s88, 90112
  s_nop 0
  buffer_load_dwordx4 v26, s[28:31], s68 offen offset:0 lds
  s_waitcnt vmcnt(10)
  s_add_u32 m0, s88, 90112
  s_nop 0
  buffer_load_dwordx4 v26, s[28:31], s68 offen offset:1024 lds
  s_add_u32 s68, s68, 4096
  s_cmp_eq_u32 s68, 90112
  s_cselect_b32 s68, 0, s68
  s_barrier
  s_waitcnt vmcnt(10)
  s_add_u32 m0, s88, 98304
  s_nop 0
  buffer_load_dwordx4 v30, s[24:27], s72 offen  lds
  s_waitcnt vmcnt(10)
  s_add_u32 m0, s88, 99328
  s_nop 0
  buffer_load_dwordx4 v31, s[24:27], s72 offen  lds
  s_add_u32 s72, s72, 262144
  s_cmp_eq_u32 s72, 5767168
  s_cselect_b32 s72, 0, s72
  s_waitcnt vmcnt(10)
  s_add_u32 m0, s88, 106496
  s_nop 0
  buffer_load_dwordx4 v26, s[28:31], s68 offen offset:0 lds
  s_waitcnt vmcnt(10)
  s_add_u32 m0, s88, 106496
  s_nop 0
  buffer_load_dwordx4 v26, s[28:31], s68 offen offset:1024 lds
  s_add_u32 s68, s68, 4096
  s_cmp_eq_u32 s68, 90112
  s_cselect_b32 s68, 0, s68
  s_barrier
  s_waitcnt vmcnt(10)
  s_add_u32 m0, s88, 114688
  s_nop 0
  buffer_load_dwordx4 v30, s[24:27], s72 offen  lds
  s_waitcnt vmcnt(10)
  s_add_u32 m0, s88, 115712
  s_nop 0
  buffer_load_dwordx4 v31, s[24:27], s72 offen  lds
  s_add_u32 s72, s72, 262144
  s_cmp_eq_u32 s72, 5767168
  s_cselect_b32 s72, 0, s72
  s_waitcnt vmcnt(10)
  s_add_u32 m0, s88, 122880
  s_nop 0
  buffer_load_dwordx4 v26, s[28:31], s68 offen offset:0 lds
  s_waitcnt vmcnt(10)
  s_add_u32 m0, s88, 122880
  s_nop 0
  buffer_load_dwordx4 v26, s[28:31], s68 offen offset:1024 lds
  s_add_u32 s68, s68, 4096
  s_cmp_eq_u32 s68, 90112
  s_cselect_b32 s68, 0, s68
  s_barrier
  s_waitcnt vmcnt(10)
  s_add_u32 m0, s88, 0
  s_nop 0
  buffer_load_dwordx4 v30, s[24:27], s72 offen  lds
  s_waitcnt vmcnt(10)
  s_add_u32 m0, s88, 1024
  s_nop 0
  buffer_load_dwordx4 v31, s[24:27], s72 offen  lds
  s_add_u32 s72, s72, 262144
  s_cmp_eq_u32 s72, 5767168
  s_cselect_b32 s72, 0, s72
  s_waitcnt vmcnt(10)
  s_add_u32 m0, s88, 8192
  s_nop 0
  buffer_load_dwordx4 v26, s[28:31], s68 offen offset:0 lds
  s_waitcnt vmcnt(10)
  s_add_u32 m0, s88, 8192
  s_nop 0
  buffer_load_dwordx4 v26, s[28:31], s68 offen offset:1024 lds
  s_add_u32 s68, s68, 4096
  s_cmp_eq_u32 s68, 90112
  s_cselect_b32 s68, 0, s68
  s_barrier
  s_waitcnt vmcnt(10)
  s_add_u32 m0, s88, 16384
  s_nop 0
  buffer_load_dwordx4 v30, s[24:27], s72 offen  lds
  s_waitcnt vmcnt(10)
  s_add_u32 m0, s88, 17408
  s_nop 0
  buffer_load_dwordx4 v31, s[24:27], s72 offen  lds
  s_add_u32 s72, s72, 262144
  s_cmp_eq_u32 s72, 5767168
  s_cselect_b32 s72, 0, s72
  s_waitcnt vmcnt(10)
  s_add_u32 m0, s88, 24576
  s_nop 0
  buffer_load_dwordx4 v26, s[28:31], s68 offen offset:0 lds
  s_waitcnt vmcnt(10)
  s_add_u32 m0, s88, 24576
  s_nop 0
  buffer_load_dwordx4 v26, s[28:31], s68 offen offset:1024 lds
  s_add_u32 s68, s68, 4096
  s_cmp_eq_u32 s68, 90112
  s_cselect_b32 s68, 0, s68
  s_barrier
  s_waitcnt vmcnt(10)
  s_add_u32 m0, s88, 32768
  s_nop 0
  buffer_load_dwordx4 v30, s[24:27], s72 offen  lds
  s_waitcnt vmcnt(10)
  s_add_u32 m0, s88, 33792
  s_nop 0
  buffer_load_dwordx4 v31, s[24:27], s72 offen  lds
  s_add_u32 s72, s72, 262144
  s_cmp_eq_u32 s72, 5767168
  s_cselect_b32 s72, 0, s72
  s_waitcnt vmcnt(10)
  s_add_u32 m0, s88, 40960
  s_nop 0
  buffer_load_dwordx4 v26, s[28:31], s68 offen offset:0 lds
  s_waitcnt vmcnt(10)
  s_add_u32 m0, s88, 40960
  s_nop 0
  buffer_load_dwordx4 v26, s[28:31], s68 offen offset:1024 lds
  s_add_u32 s68, s68, 4096
  s_cmp_eq_u32 s68, 90112
  s_cselect_b32 s68, 0, s68
  s_barrier
  s_waitcnt vmcnt(10)
  s_add_u32 m0, s88, 49152
  s_nop 0
  buffer_load_dwordx4 v30, s[24:27], s72 offen  lds
  s_waitcnt vmcnt(10)
  s_add_u32 m0, s88, 50176
  s_nop 0
  buffer_load_dwordx4 v31, s[24:27], s72 offen  lds
  s_add_u32 s72, s72, 262144
  s_cmp_eq_u32 s72, 5767168
  s_cselect_b32 s72, 0, s72
  s_waitcnt vmcnt(10)
  s_add_u32 m0, s88, 57344
  s_nop 0
  buffer_load_dwordx4 v26, s[28:31], s68 offen offset:0 lds
  s_waitcnt vmcnt(10)
  s_add_u32 m0, s88, 57344
  s_nop 0
  buffer_load_dwordx4 v26, s[28:31], s68 offen offset:1024 lds
  s_add_u32 s68, s68, 4096
  s_cmp_eq_u32 s68, 90112
  s_cselect_b32 s68, 0, s68
  s_barrier
  s_waitcnt vmcnt(10)
  s_add_u32 m0, s88, 65536
  s_nop 0
  buffer_load_dwordx4 v30, s[24:27], s72 offen  lds
  s_waitcnt vmcnt(10)
  s_add_u32 m0, s88, 66560
  s_nop 0
  buffer_load_dwordx4 v31, s[24:27], s72 offen  lds
  s_add_u32 s72, s72, 262144
  s_cmp_eq_u32 s72, 5767168
  s_cselect_b32 s72, 0, s72
  s_waitcnt vmcnt(10)
  s_add_u32 m0, s88, 73728
  s_nop 0
  buffer_load_dwordx4 v26, s[28:31], s68 offen offset:0 lds
  s_waitcnt vmcnt(10)
  s_add_u32 m0, s88, 73728
  s_nop 0
  buffer_load_dwordx4 v26, s[28:31], s68 offen offset:1024 lds
  s_add_u32 s68, s68, 4096
  s_cmp_eq_u32 s68, 90112
  s_cselect_b32 s68, 0, s68
  s_barrier
  s_waitcnt vmcnt(10)
  s_add_u32 m0, s88, 81920
  s_nop 0
  buffer_load_dwordx4 v30, s[24:27], s72 offen  lds
  s_waitcnt vmcnt(10)
  s_add_u32 m0, s88, 82944
  s_nop 0
  buffer_load_dwordx4 v31, s[24:27], s72 offen  lds
  s_add_u32 s72, s72, 262144
  s_cmp_eq_u32 s72, 5767168
  s_cselect_b32 s72, 0, s72
  s_waitcnt vmcnt(10)
  s_add_u32 m0, s88, 90112
  s_nop 0
  buffer_load_dwordx4 v26, s[28:31], s68 offen offset:0 lds
  s_waitcnt vmcnt(10)
  s_add_u32 m0, s88, 90112
  s_nop 0
  buffer_load_dwordx4 v26, s[28:31], s68 offen offset:1024 lds
  s_add_u32 s68, s68, 4096
  s_cmp_eq_u32 s68, 90112
  s_cselect_b32 s68, 0, s68
  s_barrier
  s_waitcnt vmcnt(10)
  s_add_u32 m0, s88, 98304
  s_nop 0
  buffer_load_dwordx4 v30, s[24:27], s72 offen  lds
  s_waitcnt vmcnt(10)
  s_add_u32 m0, s88, 99328
  s_nop 0
  buffer_load_dwordx4 v31, s[24:27], s72 offen  lds
  s_add_u32 s72, s72, 262144
  s_cmp_eq_u32 s72, 5767168
  s_cselect_b32 s72, 0, s72
  s_waitcnt vmcnt(10)
  s_add_u32 m0, s88, 106496
  s_nop 0
  buffer_load_dwordx4 v26, s[28:31], s68 offen offset:0 lds
  s_waitcnt vmcnt(10)
  s_add_u32 m0, s88, 106496
  s_nop 0
  buffer_load_dwordx4 v26, s[28:31], s68 offen offset:1024 lds
  s_add_u32 s68, s68, 4096
  s_cmp_eq_u32 s68, 90112
  s_cselect_b32 s68, 0, s68
  s_cmp_lg_u32 s79, 0
  s_cbranch_scc1 L_pb_82
  s_lshr_b32 s4, s89, 1
  s_lshl_b32 s4, s4, 8
  s_add_u32 s4, s4, 6504448
  v_and_b32 v13, 3, v1
  v_lshlrev_b32 v13, 6, v13
  v_add_u32 v13, s4, v13
  buffer_load_dword v12, v13, s[28:31], 0 offen sc1
L_pb_82:
  s_barrier
  s_waitcnt vmcnt(10)
  s_add_u32 m0, s88, 114688
  s_nop 0
  buffer_load_dwordx4 v30, s[24:27], s72 offen  lds
  s_waitcnt vmcnt(10)
  s_add_u32 m0, s88, 115712
  s_nop 0
  buffer_load_dwordx4 v31, s[24:27], s72 offen  lds
  s_add_u32 s72, s72, 262144
  s_cmp_eq_u32 s72, 5767168
  s_cselect_b32 s72, 0, s72
  s_waitcnt vmcnt(10)
  s_add_u32 m0, s88, 122880
  s_nop 0
  buffer_load_dwordx4 v26, s[28:31], s68 offen offset:0 lds
  s_waitcnt vmcnt(10)
  s_add_u32 m0, s88, 122880
  s_nop 0
  buffer_load_dwordx4 v26, s[28:31], s68 offen offset:1024 lds
  s_add_u32 s68, s68, 4096
  s_cmp_eq_u32 s68, 90112
  s_cselect_b32 s68, 0, s68
  s_barrier
  s_waitcnt vmcnt(10)
  s_add_u32 m0, s88, 0
  s_nop 0
  buffer_load_dwordx4 v30, s[24:27], s72 offen  lds
  s_waitcnt vmcnt(10)
  s_add_u32 m0, s88, 1024
  s_nop 0
  buffer_load_dwordx4 v31, s[24:27], s72 offen  lds
  s_add_u32 s72, s72, 262144
  s_cmp_eq_u32 s72, 5767168
  s_cselect_b32 s72, 0, s72
  s_waitcnt vmcnt(10)
  s_add_u32 m0, s88, 8192
  s_nop 0
  buffer_load_dwordx4 v26, s[28:31], s68 offen offset:0 lds
  s_waitcnt vmcnt(10)
  s_add_u32 m0, s88, 8192
  s_nop 0
  buffer_load_dwordx4 v26, s[28:31], s68 offen offset:1024 lds
  s_add_u32 s68, s68, 4096
  s_cmp_eq_u32 s68, 90112
  s_cselect_b32 s68, 0, s68
  s_barrier
  s_waitcnt vmcnt(10)
  s_add_u32 m0, s88, 16384
  s_nop 0
  buffer_load_dwordx4 v30, s[24:27], s72 offen  lds
  s_waitcnt vmcnt(10)
  s_add_u32 m0, s88, 17408
  s_nop 0
  buffer_load_dwordx4 v31, s[24:27], s72 offen  lds
  s_add_u32 s72, s72, 262144
  s_cmp_eq_u32 s72, 5767168
  s_cselect_b32 s72, 0, s72
  s_waitcnt vmcnt(10)
  s_add_u32 m0, s88, 24576
  s_nop 0
  buffer_load_dwordx4 v26, s[28:31], s68 offen offset:0 lds
  s_waitcnt vmcnt(10)
  s_add_u32 m0, s88, 24576
  s_nop 0
  buffer_load_dwordx4 v26, s[28:31], s68 offen offset:1024 lds
  s_add_u32 s68, s68, 4096
  s_cmp_eq_u32 s68, 90112
  s_cselect_b32 s68, 0, s68
  s_barrier
  s_waitcnt vmcnt(10)
  s_add_u32 m0, s88, 32768
  s_nop 0
  buffer_load_dwordx4 v30, s[24:27], s72 offen  lds
  s_waitcnt vmcnt(10)
  s_add_u32 m0, s88, 33792
  s_nop 0
  buffer_load_dwordx4 v31, s[24:27], s72 offen  lds
  s_add_u32 s72, s72, 262144
  s_cmp_eq_u32 s72, 5767168
  s_cselect_b32 s72, 0, s72
  s_waitcnt vmcnt(10)
  s_add_u32 m0, s88, 40960
  s_nop 0
  buffer_load_dwordx4 v26, s[28:31], s68 offen offset:0 lds
  s_waitcnt vmcnt(10)
  s_add_u32 m0, s88, 40960
  s_nop 0
  buffer_load_dwordx4 v26, s[28:31], s68 offen offset:1024 lds
  s_add_u32 s68, s68, 4096
  s_cmp_eq_u32 s68, 90112
  s_cselect_b32 s68, 0, s68
  s_cmp_lg_u32 s79, 0
  s_cbranch_scc1 L_gp_83
  s_mov_b32 s7, 131072
  v_cmp_gt_u32 vcc, 1, v12
  s_cbranch_vccz L_go_85
L_gs_84:
  buffer_load_dword v12, v13, s[28:31], 0 offen sc1
  s_waitcnt vmcnt(0)
  v_cmp_gt_u32 vcc, 1, v12
  s_cbranch_vccz L_go_85
  s_sub_u32 s7, s7, 1
  s_cmp_eq_u32 s7, 0
  s_cbranch_scc1 L_go_85
  s_sleep 1
  s_branch L_gs_84
L_go_85:
  v_mov_b32 v5, 162844
  v_mov_b32 v6, 1
  ds_write_b32 v5, v6
  s_branch L_gf_86
L_gp_83:
  v_mov_b32 v5, 162844
  s_mov_b32 s7, 1048576
L_ls_87:
  ds_read_b32 v6, v5
  s_waitcnt lgkmcnt(0)
  v_readfirstlane_b32 s4, v6
  s_nop 3
  s_cmp_ge_u32 s4, 1
  s_cbranch_scc1 L_lo_88
  s_sub_u32 s7, s7, 1
  s_cmp_eq_u32 s7, 0
  s_cbranch_scc1 L_lo_88
  s_sleep 1
  s_branch L_ls_87
L_lo_88:
L_gf_86:
  s_lshl_b32 s6, s90, 7
  s_lshl_b32 s4, s79, 4
  v_add_u32 v5, s4, v11
  s_mov_b32 s5, 1024
  v_mul_lo_u32 v5, v5, s5
  v_add_u32 v5, v5, v10
  v_add_u32 v24, s6, v5
  v_add_u32 v25, 8192, v24
  s_and_b32 s4, s81, 3
  s_lshl_b32 s4, s4, 1
  s_lshr_b32 s5, s81, 2
  s_add_u32 s4, s4, s5
  s_and_b32 s69, s4, 7
  s_lshl_b32 s67, s69, 16
  s_lshl_b32 s4, s89, 1
  s_lshr_b32 s5, s79, 1
  s_add_u32 s4, s4, s5
  s_lshl_b32 s4, s4, 5
  s_and_b32 s5, s79, 1
  s_lshl_b32 s5, s5, 1
  s_add_u32 s4, s4, s5
  s_lshl_b32 s4, s4, 10
  s_add_u32 s4, s4, 4194304
  v_lshlrev_b32 v5, 4, v1
  v_add_u32 v28, s4, v5
  s_lshl_b32 s70, s69, 12
  s_waitcnt vmcnt(10)
  s_add_u32 m0, s88, 131072
  s_nop 0
  buffer_load_dwordx4 v24, s[16:19], s67 offen  lds
  s_waitcnt vmcnt(10)
  s_add_u32 m0, s88, 132096
  s_nop 0
  buffer_load_dwordx4 v25, s[16:19], s67 offen  lds
  s_add_u32 s67, s67, 65536
  s_cmp_eq_u32 s67, 524288
  s_cselect_b32 s67, 0, s67
  s_waitcnt vmcnt(10)
  s_add_u32 m0, s88, 139264
  s_nop 0
  buffer_load_dwordx4 v28, s[28:31], s70 offen offset:0 lds
  s_waitcnt vmcnt(10)
  s_add_u32 m0, s88, 139264
  s_nop 0
  buffer_load_dwordx4 v28, s[28:31], s70 offen offset:1024 lds
  s_add_u32 s70, s70, 4096
  s_cmp_eq_u32 s70, 32768
  s_cselect_b32 s70, 0, s70
  s_barrier
  s_waitcnt vmcnt(10)
  s_add_u32 m0, s88, 49152
  s_nop 0
  buffer_load_dwordx4 v24, s[16:19], s67 offen  lds
  s_waitcnt vmcnt(10)
  s_add_u32 m0, s88, 50176
  s_nop 0
  buffer_load_dwordx4 v25, s[16:19], s67 offen  lds
  s_add_u32 s67, s67, 65536
  s_cmp_eq_u32 s67, 524288
  s_cselect_b32 s67, 0, s67
  s_waitcnt vmcnt(10)
  s_add_u32 m0, s88, 57344
  s_nop 0
  buffer_load_dwordx4 v28, s[28:31], s70 offen offset:0 lds
  s_waitcnt vmcnt(10)
  s_add_u32 m0, s88, 57344
  s_nop 0
  buffer_load_dwordx4 v28, s[28:31], s70 offen offset:1024 lds
  s_add_u32 s70, s70, 4096
  s_cmp_eq_u32 s70, 32768
  s_cselect_b32 s70, 0, s70
  s_barrier
  s_waitcnt vmcnt(10)
  s_add_u32 m0, s88, 65536
  s_nop 0
  buffer_load_dwordx4 v24, s[16:19], s67 offen  lds
  s_waitcnt vmcnt(10)
  s_add_u32 m0, s88, 66560
  s_nop 0
  buffer_load_dwordx4 v25, s[16:19], s67 offen  lds
  s_add_u32 s67, s67, 65536
  s_cmp_eq_u32 s67, 524288
  s_cselect_b32 s67, 0, s67
  s_waitcnt vmcnt(10)
  s_add_u32 m0, s88, 73728
  s_nop 0
  buffer_load_dwordx4 v28, s[28:31], s70 offen offset:0 lds
  s_waitcnt vmcnt(10)
  s_add_u32 m0, s88, 73728
  s_nop 0
  buffer_load_dwordx4 v28, s[28:31], s70 offen offset:1024 lds
  s_add_u32 s70, s70, 4096
  s_cmp_eq_u32 s70, 32768
  s_cselect_b32 s70, 0, s70
  s_barrier
  s_waitcnt vmcnt(10)
  s_add_u32 m0, s88, 81920
  s_nop 0
  buffer_load_dwordx4 v24, s[16:19], s67 offen  lds
  s_waitcnt vmcnt(10)
  s_add_u32 m0, s88, 82944
  s_nop 0
  buffer_load_dwordx4 v25, s[16:19], s67 offen  lds
  s_add_u32 s67, s67, 65536
  s_cmp_eq_u32 s67, 524288
  s_cselect_b32 s67, 0, s67
  s_waitcnt vmcnt(10)
  s_add_u32 m0, s88, 90112
  s_nop 0
  buffer_load_dwordx4 v28, s[28:31], s70 offen offset:0 lds
  s_waitcnt vmcnt(10)
  s_add_u32 m0, s88, 90112
  s_nop 0
  buffer_load_dwordx4 v28, s[28:31], s70 offen offset:1024 lds
  s_add_u32 s70, s70, 4096
  s_cmp_eq_u32 s70, 32768
  s_cselect_b32 s70, 0, s70
  s_barrier
  s_waitcnt vmcnt(10)
  s_add_u32 m0, s88, 98304
  s_nop 0
  buffer_load_dwordx4 v24, s[16:19], s67 offen  lds
  s_waitcnt vmcnt(10)
  s_add_u32 m0, s88, 99328
  s_nop 0
  buffer_load_dwordx4 v25, s[16:19], s67 offen  lds
  s_add_u32 s67, s67, 65536
  s_cmp_eq_u32 s67, 524288
  s_cselect_b32 s67, 0, s67
  s_waitcnt vmcnt(10)
  s_add_u32 m0, s88, 106496
  s_nop 0
  buffer_load_dwordx4 v28, s[28:31], s70 offen offset:0 lds
  s_waitcnt vmcnt(10)
  s_add_u32 m0, s88, 106496
  s_nop 0
  buffer_load_dwordx4 v28, s[28:31], s70 offen offset:1024 lds
  s_add_u32 s70, s70, 4096
  s_cmp_eq_u32 s70, 32768
  s_cselect_b32 s70, 0, s70
  s_barrier
  s_waitcnt vmcnt(10)
  s_add_u32 m0, s88, 114688
  s_nop 0
  buffer_load_dwordx4 v24, s[16:19], s67 offen  lds
  s_waitcnt vmcnt(10)
  s_add_u32 m0, s88, 115712
  s_nop 0
  buffer_load_dwordx4 v25, s[16:19], s67 offen  lds
  s_add_u32 s67, s67, 65536
  s_cmp_eq_u32 s67, 524288
  s_cselect_b32 s67, 0, s67
  s_waitcnt vmcnt(10)
  s_add_u32 m0, s88, 122880
  s_nop 0
  buffer_load_dwordx4 v28, s[28:31], s70 offen offset:0 lds
  s_waitcnt vmcnt(10)
  s_add_u32 m0, s88, 122880
  s_nop 0
  buffer_load_dwordx4 v28, s[28:31], s70 offen offset:1024 lds
  s_add_u32 s70, s70, 4096
  s_cmp_eq_u32 s70, 32768
  s_cselect_b32 s70, 0, s70
  s_barrier
  s_waitcnt vmcnt(10)
  s_add_u32 m0, s88, 0
  s_nop 0
  buffer_load_dwordx4 v24, s[16:19], s67 offen  lds
  s_waitcnt vmcnt(10)
  s_add_u32 m0, s88, 1024
  s_nop 0
  buffer_load_dwordx4 v25, s[16:19], s67 offen  lds
  s_add_u32 s67, s67, 65536
  s_cmp_eq_u32 s67, 524288
  s_cselect_b32 s67, 0, s67
  s_waitcnt vmcnt(10)
  s_add_u32 m0, s88, 8192
  s_nop 0
  buffer_load_dwordx4 v28, s[28:31], s70 offen offset:0 lds
  s_waitcnt vmcnt(10)
  s_add_u32 m0, s88, 8192
  s_nop 0
  buffer_load_dwordx4 v28, s[28:31], s70 offen offset:1024 lds
  s_add_u32 s70, s70, 4096
  s_cmp_eq_u32 s70, 32768
  s_cselect_b32 s70, 0, s70
  s_barrier
  s_waitcnt vmcnt(10)
  s_add_u32 m0, s88, 16384
  s_nop 0
  buffer_load_dwordx4 v24, s[16:19], s67 offen  lds
  s_waitcnt vmcnt(10)
  s_add_u32 m0, s88, 17408
  s_nop 0
  buffer_load_dwordx4 v25, s[16:19], s67 offen  lds
  s_add_u32 s67, s67, 65536
  s_cmp_eq_u32 s67, 524288
  s_cselect_b32 s67, 0, s67
  s_waitcnt vmcnt(10)
  s_add_u32 m0, s88, 24576
  s_nop 0
  buffer_load_dwordx4 v28, s[28:31], s70 offen offset:0 lds
  s_waitcnt vmcnt(10)
  s_add_u32 m0, s88, 24576
  s_nop 0
  buffer_load_dwordx4 v28, s[28:31], s70 offen offset:1024 lds
  s_add_u32 s70, s70, 4096
  s_cmp_eq_u32 s70, 32768
  s_cselect_b32 s70, 0, s70
  s_barrier
  s_barrier
  s_barrier
  s_barrier
  s_barrier
  s_waitcnt vmcnt(8)
  s_barrier
  s_waitcnt vmcnt(4)
  s_barrier
  s_waitcnt vmcnt(0)
  s_barrier
  s_waitcnt vmcnt(0)
L_end:
  s_endpgm
L_code_end:

.section .rodata,"a"
.p2align 6
.amdhsa_kernel gated_mix__linear_kernel_hedgehog__mixer_token_mlp__prompt_kernel
  .amdhsa_next_free_vgpr 256
  .amdhsa_next_free_sgpr 102
  .amdhsa_accum_offset 128
  .amdhsa_group_segment_fixed_size 0
  .amdhsa_kernarg_size 104
  .amdhsa_user_sgpr_count 2
  .amdhsa_user_sgpr_kernarg_segment_ptr 1
  .amdhsa_system_sgpr_workgroup_id_x 1
.end_amdhsa_kernel
```
